```python
import torch

def _softmax(x, axis=-1):
    return torch.softmax(x, dim=axis)
def _gelu(x):
    return torch.nn.functional.gelu(x, approximate="tanh")
def _silu(x):
    return torch.nn.functional.silu(x)
def _sigmoid(x):
    return torch.sigmoid(x)
def _layernorm(x, axis=-1, eps=1e-5):
    m = x.mean(dim=axis, keepdim=True)
    v = x.var(dim=axis, keepdim=True, unbiased=False)
    return (x - m) / torch.sqrt(v + eps)
def _scatter_add(tgt, idx, src, axis=0):
    return tgt.clone().index_add_(axis, idx, src)
def _segment_sum(src, seg, n):
    out = torch.zeros((n,) + src.shape[1:], dtype=src.dtype)
    return out.index_add_(0, seg, src)
def _pad(x, pw):
    flat = tuple(v for pair in reversed(pw) for v in pair)
    return torch.nn.functional.pad(x, flat)

kernel_name = 'concat_heads__gqa_block_cached__sliding_block_cached__decode'

def setup_inputs():

    _w = (lambda a: (lambda t: t.to(torch.bfloat16) if t.is_floating_point() else t)(torch.as_tensor(a)))
    def _A_setup():
        B, Sq, D = 1, 1, 512
        Hq, Hkv, Sk, Dh = 32, 8, 32768, 128
        assert Hq % Hkv == 0, (Hq, Hkv)
        return {
            "x": _w((lambda *s: torch.randn(*s, dtype=torch.bfloat16) * 0.8)(B, Sq, D)),
            "k_cache": _w((lambda *s: torch.randn(*s, dtype=torch.bfloat16) * 1.6)(B, Hkv, Sk, Dh)),
            "v_cache": _w((lambda *s: torch.randn(*s, dtype=torch.bfloat16) * 0.2)(B, Hkv, Sk, Dh)),
            "wq": _w((lambda *s: torch.randn(*s, dtype=torch.bfloat16) * 1.6)(D, Hq * Dh) * (D ** -0.5)),
            "wo": _w((lambda *s: torch.randn(*s, dtype=torch.bfloat16) * 0.2)(Hq * Dh, D) * ((Hq * Dh) ** -0.5)),
        }
    _A_in = _A_setup()

    def _B_setup():
        B, Sq, D = 1, 1, 512
        Hq, Hkv, Sk, Dh = 32, 8, 32768, 128
        assert Hq % Hkv == 0, (Hq, Hkv)
        return {
            "x": _w((lambda *s: torch.randn(*s, dtype=torch.bfloat16) * 0.8)(B, Sq, D)),
            "k_cache": _w((lambda *s: torch.randn(*s, dtype=torch.bfloat16) * 1.6)(B, Hkv, Sk, Dh)),
            "v_cache": _w((lambda *s: torch.randn(*s, dtype=torch.bfloat16) * 0.2)(B, Hkv, Sk, Dh)),
            "wq": _w((lambda *s: torch.randn(*s, dtype=torch.bfloat16) * 1.6)(D, Hq * Dh) * (D ** -0.5)),
            "wo": _w((lambda *s: torch.randn(*s, dtype=torch.bfloat16) * 0.2)(Hq * Dh, D) * ((Hq * Dh) ** -0.5)),
        }
    _B_in = _B_setup()

    return {
        "A_x": _A_in["x"],
        "A_k_cache": _A_in["k_cache"],
        "A_v_cache": _A_in["v_cache"],
        "A_wq": _A_in["wq"],
        "A_wo": _A_in["wo"],
        "B_x": _B_in["x"],
        "B_k_cache": _B_in["k_cache"],
        "B_v_cache": _B_in["v_cache"],
        "B_wq": _B_in["wq"],
        "B_wo": _B_in["wo"],
    }

def reference(A_x, A_k_cache, A_v_cache, A_wq, A_wo, B_x, B_k_cache, B_v_cache, B_wq, B_wo):
    def _A_ref(x, k_cache, v_cache, wq, wo):
        B, Sq, D = x.shape
        Hq, Dh = 32, 128
        Hkv = k_cache.shape[1]
        rep = Hq // Hkv
        q = (lambda x, *d: x.permute(*d))((x @ wq).reshape(B, Sq, Hq, Dh), 0, 2, 1, 3)
        k = (lambda x, n, axis: torch.repeat_interleave(x, n, dim=axis))(k_cache, rep, axis=1)
        v = (lambda x, n, axis: torch.repeat_interleave(x, n, dim=axis))(v_cache, rep, axis=1)
        scores = torch.einsum("bhqd,bhkd->bhqk", q, k) * (Dh ** -0.5)
        p = _softmax(scores, axis=-1)
        o = torch.einsum("bhqk,bhkd->bhqd", p, v)
        return (lambda x, *d: x.permute(*d))(o, 0, 2, 1, 3).reshape(B, Sq, Hq * Dh) @ wo

    def _B_ref(x, k_cache, v_cache, wq, wo):
        B, Sq, D = x.shape
        Hq, Dh = 32, 128
        Hkv, Sk = k_cache.shape[1], k_cache.shape[2]
        W = min(4096, max(256, Sk // 4))
        rep = Hq // Hkv
        q = (lambda x, *d: x.permute(*d))((x @ wq).reshape(B, Sq, Hq, Dh), 0, 2, 1, 3)
        k = (lambda x, n, axis: torch.repeat_interleave(x, n, dim=axis))(k_cache[:, :, Sk - W:, :], rep, axis=1)
        v = (lambda x, n, axis: torch.repeat_interleave(x, n, dim=axis))(v_cache[:, :, Sk - W:, :], rep, axis=1)
        scores = torch.einsum("bhqd,bhkd->bhqk", q, k) * (Dh ** -0.5)
        p = _softmax(scores, axis=-1)
        o = torch.einsum("bhqk,bhkd->bhqd", p, v)
        return (lambda x, *d: x.permute(*d))(o, 0, 2, 1, 3).reshape(B, Sq, Hq * Dh) @ wo

    a = _A_ref(A_x, A_k_cache, A_v_cache, A_wq, A_wo)
    b = _B_ref(B_x, B_k_cache, B_v_cache, B_wq, B_wo)
    return torch.concatenate([a, b], axis=-1)
```

```asm
; @launch grid=(256,1,1) block=(512,1,1) lds=151552
.amdgcn_target "amdgcn-amd-amdhsa--gfx950"
.text
.globl concat_heads__gqa_block_cached__sliding_block_cached__decode_kernel
.p2align 8
.type concat_heads__gqa_block_cached__sliding_block_cached__decode_kernel,@function
concat_heads__gqa_block_cached__sliding_block_cached__decode_kernel:
    s_cmp_ge_u32 s2, 256
    s_cbranch_scc1 L_end
    s_load_dwordx16 s[16:31], s[0:1], 0
    s_load_dwordx8 s[32:39], s[0:1], 64
    s_load_dwordx2 s[40:41], s[0:1], 96
    s_and_b32 s3, s2, 7
    s_lshr_b32 s4, s2, 3
    v_and_b32 v8, 63, v0
    v_lshrrev_b32 v9, 6, v0
    s_nop 0
    v_readfirstlane_b32 s5, v9
    s_lshr_b32 s84, s4, 4
    s_bfe_u32 s86, s4, 0x20002
    s_and_b32 s87, s4, 3
    s_lshl_b32 s88, s3, 2
    s_add_u32 s88, s88, s86
    s_lshl_b32 s14, s3, 10
    v_lshrrev_b32 v39, 4, v8
    v_lshl_add_u32 v84, v9, 4, v39
    v_lshlrev_b32 v85, 13, v84
    v_and_b32 v86, 15, v0
    v_lshl_add_u32 v85, v86, 4, v85
    v_lshlrev_b32 v84, 1, v84
    s_lshl_b32 s89, s86, 20
    s_lshl_b32 s9, s87, 8
    s_add_u32 s89, s89, s9
    s_add_u32 s89, s89, s14
    s_lshl_b32 s85, s86, 8
    v_lshrrev_b32 v87, 4, v0
    v_lshlrev_b32 v87, 12, v87
    v_lshl_add_u32 v87, v86, 4, v87
    s_lshl_b32 s9, s88, 17
    s_lshl_b32 s10, s87, 8
    s_add_u32 s11, s9, s10
    s_waitcnt lgkmcnt(0)
    s_cmp_eq_u32 s84, 1
    s_cselect_b32 s64, s32, s22
    s_cselect_b32 s65, s33, s23
    s_and_b32 s65, s65, 0xffff
    s_mov_b32 s66, 0x400000
    s_mov_b32 s67, 0x00020000
    s_cmp_eq_u32 s84, 1
    s_cselect_b32 s68, s26, s16
    s_cselect_b32 s69, s27, s17
    s_and_b32 s69, s69, 0xffff
    s_mov_b32 s70, 0x400
    s_mov_b32 s71, 0x00020000
    s_add_u32 s9, s89, 0
    buffer_load_dwordx4 v[56:59], v85, s[64:67], s9 offen nt
    s_add_u32 s9, s89, 32768
    buffer_load_dwordx4 v[60:63], v85, s[64:67], s9 offen nt
    s_add_u32 s9, s89, 65536
    buffer_load_dwordx4 v[64:67], v85, s[64:67], s9 offen nt
    s_add_u32 s9, s89, 98304
    buffer_load_dwordx4 v[68:71], v85, s[64:67], s9 offen nt
    buffer_load_ushort v72, v84, s[68:71], s85 offen offset:0
    buffer_load_ushort v73, v84, s[68:71], s85 offen offset:8
    buffer_load_ushort v74, v84, s[68:71], s85 offen offset:16
    buffer_load_ushort v75, v84, s[68:71], s85 offen offset:24
    s_cmp_eq_u32 s84, 1
    s_cselect_b32 s72, s34, s24
    s_cselect_b32 s73, s35, s25
    s_and_b32 s73, s73, 0xffff
    s_mov_b32 s74, 0x400000
    s_mov_b32 s75, 0x00020000
    s_mov_b32 s44, s18
    s_and_b32 s45, s19, 0xffff
    s_mov_b32 s46, 0x4000000
    s_mov_b32 s47, 0x00020000
    s_mov_b32 s48, s20
    s_and_b32 s49, s21, 0xffff
    s_mov_b32 s50, 0x4000000
    s_mov_b32 s51, 0x00020000
    s_mov_b32 s52, s28
    s_and_b32 s53, s29, 0xffff
    s_mov_b32 s54, 0x4000000
    s_mov_b32 s55, 0x00020000
    s_mov_b32 s56, s30
    s_and_b32 s57, s31, 0xffff
    s_mov_b32 s58, 0x4000000
    s_mov_b32 s59, 0x00020000
    s_mov_b32 s60, s40
    s_and_b32 s61, s41, 0xffff
    s_mov_b32 s62, 0x300000
    s_mov_b32 s63, 0x00020000
    s_mov_b32 s76, s38
    s_and_b32 s77, s39, 0xffff
    s_mov_b32 s78, 0x100
    s_mov_b32 s79, 0x00020000
    s_mov_b32 s80, s36
    s_and_b32 s81, s37, 0xffff
    s_mov_b32 s82, 0x800
    s_mov_b32 s83, 0x00020000
    v_lshlrev_b32 v2, 4, v8
    v_bfe_u32 v9, v8, 2, 2
    v_lshlrev_b32 v1, 8, v9
    v_lshl_add_u32 v1, v39, 6, v1
    v_and_b32 v36, 3, v8
    v_lshl_add_u32 v1, v36, 4, v1
    v_lshlrev_b32 v7, 9, v9
    v_lshl_add_u32 v7, v39, 7, v7
    v_lshl_add_u32 v7, v36, 2, v7
    s_mul_i32 s95, s5, 18432
    s_add_u32 s95, s95, 4096
    v_add_u32 v7, s95, v7
    v_add_u32 v239, s95, v2
    s_lshl_b32 s6, s3, 23
    s_lshl_b32 s7, s4, 18
    s_lshl_b32 s8, s5, 15
    s_add_u32 s7, s7, s8
    s_add_u32 s12, s6, s7
    s_lshl_b32 s7, s4, 15
    s_lshl_b32 s8, s5, 12
    s_add_u32 s7, s7, s8
    s_add_u32 s13, s6, s7
    s_add_u32 s13, s13, 7340032
    s_mov_b32 s15, 0x3e0293ee
    s_cmp_eq_u32 s5, 0
    s_cbranch_scc1 L_w0_pre
    s_add_u32 s6, s12, 0
    buffer_load_dwordx4 v[88:91], v1, s[44:47], s6 offen offset:0 nt
    s_add_u32 s6, s12, 0
    buffer_load_dwordx4 v[92:95], v1, s[44:47], s6 offen offset:1024 nt
    s_add_u32 s6, s12, 0
    buffer_load_dwordx4 v[96:99], v1, s[44:47], s6 offen offset:2048 nt
    s_add_u32 s6, s12, 0
    buffer_load_dwordx4 v[100:103], v1, s[44:47], s6 offen offset:3072 nt
    s_add_u32 s6, s12, 4096
    buffer_load_dwordx4 v[104:107], v1, s[44:47], s6 offen offset:0 nt
    s_add_u32 s6, s12, 4096
    buffer_load_dwordx4 v[108:111], v1, s[44:47], s6 offen offset:1024 nt
    s_add_u32 s6, s12, 4096
    buffer_load_dwordx4 v[112:115], v1, s[44:47], s6 offen offset:2048 nt
    s_add_u32 s6, s12, 4096
    buffer_load_dwordx4 v[116:119], v1, s[44:47], s6 offen offset:3072 nt
    s_add_u32 s6, s12, 8192
    buffer_load_dwordx4 v[120:123], v1, s[44:47], s6 offen offset:0 nt
    s_add_u32 s6, s12, 8192
    buffer_load_dwordx4 v[124:127], v1, s[44:47], s6 offen offset:1024 nt
    s_add_u32 s6, s12, 8192
    buffer_load_dwordx4 v[128:131], v1, s[44:47], s6 offen offset:2048 nt
    s_add_u32 s6, s12, 8192
    buffer_load_dwordx4 v[132:135], v1, s[44:47], s6 offen offset:3072 nt
    s_add_u32 s6, s12, 12288
    buffer_load_dwordx4 v[136:139], v1, s[44:47], s6 offen offset:0 nt
    s_add_u32 s6, s12, 12288
    buffer_load_dwordx4 v[140:143], v1, s[44:47], s6 offen offset:1024 nt
    s_add_u32 s6, s12, 12288
    buffer_load_dwordx4 v[144:147], v1, s[44:47], s6 offen offset:2048 nt
    s_add_u32 s6, s12, 12288
    buffer_load_dwordx4 v[148:151], v1, s[44:47], s6 offen offset:3072 nt
    s_waitcnt vmcnt(16)
    s_branch L_q_calc
L_w0_pre:
    v_mov_b32 v88, 0
    v_mov_b32 v89, 0
    v_mov_b32 v90, 0
    v_mov_b32 v91, 0
    v_lshrrev_b32 v92, 5, v8
    v_lshlrev_b32 v92, 14, v92
    v_and_b32 v93, 31, v8
    v_lshl_add_u32 v92, v93, 4, v92
    s_lshl_b32 s6, s3, 16
    s_lshl_b32 s7, s4, 9
    s_add_u32 s6, s6, s7
    s_add_u32 s6, s6, 0x100000
    s_add_u32 s7, s6, 0x0
    buffer_store_dwordx4 v[88:91], v92, s[60:63], s7 offen sc1
    s_add_u32 s7, s6, 0x8000
    buffer_store_dwordx4 v[88:91], v92, s[60:63], s7 offen sc1
    s_add_u32 s7, s6, 0x80000
    buffer_store_dwordx4 v[88:91], v92, s[60:63], s7 offen sc1
    s_add_u32 s7, s6, 0x88000
    buffer_store_dwordx4 v[88:91], v92, s[60:63], s7 offen sc1
    v_lshrrev_b32 v92, 2, v8
    v_lshlrev_b32 v92, 13, v92
    v_and_b32 v93, 3, v8
    v_lshl_add_u32 v92, v93, 8, v92
    s_lshl_b32 s6, s3, 10
    s_lshl_b32 s7, s4, 3
    s_add_u32 s6, s6, s7
    s_add_u32 s6, s6, 0x8000
    s_mov_b64 exec, 0xff
    buffer_store_dwordx2 v[88:89], v92, s[60:63], s6 offen sc1
    s_mov_b32 exec_lo, -1
    s_mov_b32 exec_hi, 0
    s_lshl_b32 s6, s84, 2
    s_add_u32 s6, s6, s87
    s_lshl_b32 s6, s6, 5
    s_add_u32 s6, s6, s88
    s_lshl_b32 s6, s6, 9
    s_add_u32 s6, s6, 0x40000
    buffer_store_dwordx4 v[88:91], v2, s[60:63], s6 offen sc1
    s_mov_b64 exec, -1
    s_waitcnt vmcnt(6)
L_q_calc:
    v_lshlrev_b32 v84, 16, v72
    v_lshlrev_b32 v85, 16, v56
    v_and_b32 v86, 0xffff0000, v56
    v_mul_f32 v76, v84, v85
    v_mul_f32 v77, v84, v86
    v_lshlrev_b32 v85, 16, v57
    v_and_b32 v86, 0xffff0000, v57
    v_mul_f32 v78, v84, v85
    v_mul_f32 v79, v84, v86
    v_lshlrev_b32 v85, 16, v58
    v_and_b32 v86, 0xffff0000, v58
    v_mul_f32 v80, v84, v85
    v_mul_f32 v81, v84, v86
    v_lshlrev_b32 v85, 16, v59
    v_and_b32 v86, 0xffff0000, v59
    v_mul_f32 v82, v84, v85
    v_mul_f32 v83, v84, v86
    v_lshlrev_b32 v84, 16, v73
    v_lshlrev_b32 v85, 16, v60
    v_and_b32 v86, 0xffff0000, v60
    v_fmac_f32 v76, v84, v85
    v_fmac_f32 v77, v84, v86
    v_lshlrev_b32 v85, 16, v61
    v_and_b32 v86, 0xffff0000, v61
    v_fmac_f32 v78, v84, v85
    v_fmac_f32 v79, v84, v86
    v_lshlrev_b32 v85, 16, v62
    v_and_b32 v86, 0xffff0000, v62
    v_fmac_f32 v80, v84, v85
    v_fmac_f32 v81, v84, v86
    v_lshlrev_b32 v85, 16, v63
    v_and_b32 v86, 0xffff0000, v63
    v_fmac_f32 v82, v84, v85
    v_fmac_f32 v83, v84, v86
    v_lshlrev_b32 v84, 16, v74
    v_lshlrev_b32 v85, 16, v64
    v_and_b32 v86, 0xffff0000, v64
    v_fmac_f32 v76, v84, v85
    v_fmac_f32 v77, v84, v86
    v_lshlrev_b32 v85, 16, v65
    v_and_b32 v86, 0xffff0000, v65
    v_fmac_f32 v78, v84, v85
    v_fmac_f32 v79, v84, v86
    v_lshlrev_b32 v85, 16, v66
    v_and_b32 v86, 0xffff0000, v66
    v_fmac_f32 v80, v84, v85
    v_fmac_f32 v81, v84, v86
    v_lshlrev_b32 v85, 16, v67
    v_and_b32 v86, 0xffff0000, v67
    v_fmac_f32 v82, v84, v85
    v_fmac_f32 v83, v84, v86
    v_lshlrev_b32 v84, 16, v75
    v_lshlrev_b32 v85, 16, v68
    v_and_b32 v86, 0xffff0000, v68
    v_fmac_f32 v76, v84, v85
    v_fmac_f32 v77, v84, v86
    v_lshlrev_b32 v85, 16, v69
    v_and_b32 v86, 0xffff0000, v69
    v_fmac_f32 v78, v84, v85
    v_fmac_f32 v79, v84, v86
    v_lshlrev_b32 v85, 16, v70
    v_and_b32 v86, 0xffff0000, v70
    v_fmac_f32 v80, v84, v85
    v_fmac_f32 v81, v84, v86
    v_lshlrev_b32 v85, 16, v71
    v_and_b32 v86, 0xffff0000, v71
    v_fmac_f32 v82, v84, v85
    v_fmac_f32 v83, v84, v86
    v_lshrrev_b32 v84, 4, v0
    v_lshlrev_b32 v84, 9, v84
    v_and_b32 v86, 15, v0
    v_lshl_add_u32 v84, v86, 5, v84
    ds_write_b128 v84, v[76:79] offset:4096
    ds_write_b128 v84, v[80:83] offset:4112
    v_mov_b32 v3, 0
    v_mov_b32 v4, 0
    v_mov_b32 v37, 0xffff
    v_mov_b32 v38, 0xffff0000
    v_cmp_eq_u32 vcc, 0, v36
    s_nop 1
    v_cndmask_b32 v3, v3, v37, vcc
    v_cmp_eq_u32 vcc, 1, v36
    s_nop 1
    v_cndmask_b32 v3, v3, v38, vcc
    v_cmp_eq_u32 vcc, 2, v36
    s_nop 1
    v_cndmask_b32 v4, v4, v37, vcc
    v_cmp_eq_u32 vcc, 3, v36
    s_nop 1
    v_cndmask_b32 v4, v4, v38, vcc
    v_xor_b32 v5, 16, v8
    v_lshlrev_b32 v5, 2, v5
    v_xor_b32 v6, 32, v8
    v_lshlrev_b32 v6, 2, v6
    v_mov_b32 v18, 0
    v_mov_b32 v19, 0
    v_mov_b32 v22, 0
    v_mov_b32 v23, 0
    v_mov_b32 v26, 0
    v_mov_b32 v27, 0
    v_and_b32 v237, 7, v8
    v_lshlrev_b32 v237, 4, v237
    s_waitcnt lgkmcnt(0)
    s_barrier
    s_cmp_eq_u32 s5, 0
    s_cbranch_scc1 L_w0_q
    s_barrier
    buffer_load_dwordx4 v[240:243], v87, s[72:75], s11 offen offset:0 nt
    buffer_load_dwordx4 v[244:247], v87, s[72:75], s11 offen offset:1024 nt
    buffer_load_dwordx4 v[248:251], v87, s[72:75], s11 offen offset:2048 nt
    buffer_load_dwordx4 v[252:255], v87, s[72:75], s11 offen offset:3072 nt
    s_add_u32 s6, s12, 16384
    buffer_load_dwordx4 v[152:155], v1, s[44:47], s6 offen offset:0 nt
    s_add_u32 s6, s12, 16384
    buffer_load_dwordx4 v[156:159], v1, s[44:47], s6 offen offset:1024 nt
    s_add_u32 s6, s12, 16384
    buffer_load_dwordx4 v[160:163], v1, s[44:47], s6 offen offset:2048 nt
    s_add_u32 s6, s12, 16384
    buffer_load_dwordx4 v[164:167], v1, s[44:47], s6 offen offset:3072 nt
    s_add_u32 s6, s12, 20480
    buffer_load_dwordx4 v[168:171], v1, s[44:47], s6 offen offset:0 nt
    s_add_u32 s6, s12, 20480
    buffer_load_dwordx4 v[172:175], v1, s[44:47], s6 offen offset:1024 nt
    s_add_u32 s6, s12, 20480
    buffer_load_dwordx4 v[176:179], v1, s[44:47], s6 offen offset:2048 nt
    s_add_u32 s6, s12, 20480
    buffer_load_dwordx4 v[180:183], v1, s[44:47], s6 offen offset:3072 nt
    s_add_u32 s6, s12, 24576
    buffer_load_dwordx4 v[184:187], v1, s[44:47], s6 offen offset:0 nt
    s_add_u32 s6, s12, 24576
    buffer_load_dwordx4 v[188:191], v1, s[44:47], s6 offen offset:1024 nt
    s_add_u32 s6, s12, 24576
    buffer_load_dwordx4 v[192:195], v1, s[44:47], s6 offen offset:2048 nt
    s_add_u32 s6, s12, 24576
    buffer_load_dwordx4 v[196:199], v1, s[44:47], s6 offen offset:3072 nt
    s_add_u32 s6, s12, 28672
    buffer_load_dwordx4 v[200:203], v1, s[44:47], s6 offen offset:0 nt
    s_add_u32 s6, s12, 28672
    buffer_load_dwordx4 v[204:207], v1, s[44:47], s6 offen offset:1024 nt
    s_waitcnt vmcnt(13)
    s_add_u32 s6, s12, 28672
    buffer_load_dwordx4 v[208:211], v1, s[44:47], s6 offen offset:2048 nt
    s_waitcnt vmcnt(13)
    s_add_u32 s6, s12, 28672
    buffer_load_dwordx4 v[212:215], v1, s[44:47], s6 offen offset:3072 nt
    s_waitcnt vmcnt(13)
    s_add_u32 s6, s12, 0
    buffer_load_dwordx4 v[216:219], v2, s[48:51], s6 offen offset:0 nt
    s_waitcnt vmcnt(13)
    s_add_u32 s6, s12, 0
    buffer_load_dwordx4 v[220:223], v2, s[48:51], s6 offen offset:1024 nt
    s_waitcnt vmcnt(13)
    s_add_u32 s6, s12, 0
    buffer_load_dwordx4 v[224:227], v2, s[48:51], s6 offen offset:2048 nt
    s_waitcnt vmcnt(13)
    s_add_u32 s6, s12, 0
    buffer_load_dwordx4 v[228:231], v2, s[48:51], s6 offen offset:3072 nt
    s_waitcnt vmcnt(13)
    s_add_u32 s6, s12, 4096
    buffer_load_dwordx4 v[232:235], v2, s[48:51], s6 offen offset:0 nt
    s_waitcnt vmcnt(13)
    s_add_u32 s6, s12, 5120
    s_add_u32 m0, s95, 0
    s_nop 0
    buffer_load_dwordx4 v2, s[48:51], s6 offen nt lds
    s_waitcnt vmcnt(13)
    s_add_u32 s6, s12, 6144
    s_add_u32 m0, s95, 1024
    s_nop 0
    buffer_load_dwordx4 v2, s[48:51], s6 offen nt lds
    s_waitcnt vmcnt(13)
    s_add_u32 s6, s12, 7168
    s_add_u32 m0, s95, 2048
    s_nop 0
    buffer_load_dwordx4 v2, s[48:51], s6 offen nt lds
    s_waitcnt vmcnt(13)
    s_add_u32 s6, s12, 8192
    s_add_u32 m0, s95, 3072
    s_nop 0
    buffer_load_dwordx4 v2, s[48:51], s6 offen nt lds
    s_waitcnt vmcnt(13)
    s_add_u32 s6, s12, 9216
    s_add_u32 m0, s95, 4096
    s_nop 0
    buffer_load_dwordx4 v2, s[48:51], s6 offen nt lds
    s_waitcnt vmcnt(13)
    s_add_u32 s6, s12, 10240
    s_add_u32 m0, s95, 5120
    s_nop 0
    buffer_load_dwordx4 v2, s[48:51], s6 offen nt lds
    s_waitcnt vmcnt(13)
    s_add_u32 s6, s12, 11264
    s_add_u32 m0, s95, 6144
    s_nop 0
    buffer_load_dwordx4 v2, s[48:51], s6 offen nt lds
    s_waitcnt vmcnt(13)
    s_add_u32 s6, s12, 12288
    s_add_u32 m0, s95, 7168
    s_nop 0
    buffer_load_dwordx4 v2, s[48:51], s6 offen nt lds
    s_waitcnt vmcnt(13)
    s_add_u32 s6, s12, 13312
    s_add_u32 m0, s95, 8192
    s_nop 0
    buffer_load_dwordx4 v2, s[48:51], s6 offen nt lds
    s_waitcnt vmcnt(13)
    s_add_u32 s6, s12, 14336
    s_add_u32 m0, s95, 9216
    s_nop 0
    buffer_load_dwordx4 v2, s[48:51], s6 offen nt lds
    s_waitcnt vmcnt(13)
    s_add_u32 s6, s12, 15360
    s_add_u32 m0, s95, 10240
    s_nop 0
    buffer_load_dwordx4 v2, s[48:51], s6 offen nt lds
    s_waitcnt vmcnt(13)
    s_add_u32 s6, s12, 16384
    s_add_u32 m0, s95, 11264
    s_nop 0
    buffer_load_dwordx4 v2, s[48:51], s6 offen nt lds
    s_waitcnt vmcnt(13)
    s_add_u32 s6, s12, 17408
    s_add_u32 m0, s95, 12288
    s_nop 0
    buffer_load_dwordx4 v2, s[48:51], s6 offen nt lds
    s_waitcnt vmcnt(13)
    s_add_u32 s6, s12, 18432
    s_add_u32 m0, s95, 13312
    s_nop 0
    buffer_load_dwordx4 v2, s[48:51], s6 offen nt lds
    s_waitcnt vmcnt(13)
    s_add_u32 s6, s12, 19456
    s_add_u32 m0, s95, 14336
    s_nop 0
    buffer_load_dwordx4 v2, s[48:51], s6 offen nt lds
    s_waitcnt vmcnt(13)
    s_add_u32 s6, s12, 20480
    s_add_u32 m0, s95, 15360
    s_nop 0
    buffer_load_dwordx4 v2, s[48:51], s6 offen nt lds
    s_waitcnt vmcnt(13)
    s_add_u32 s6, s12, 21504
    s_add_u32 m0, s95, 16384
    s_nop 0
    buffer_load_dwordx4 v2, s[48:51], s6 offen nt lds
    s_waitcnt vmcnt(13)
    s_add_u32 s6, s12, 22528
    s_add_u32 m0, s95, 17408
    s_nop 0
    buffer_load_dwordx4 v2, s[48:51], s6 offen nt lds
    s_branch L_q_wait
L_w0_q:
    v_lshlrev_b32 v85, 3, v8
    ds_read_b64 v[88:89], v85 offset:4096
    ds_read_b64 v[90:91], v85 offset:4608
    ds_read_b64 v[92:93], v85 offset:5120
    ds_read_b64 v[94:95], v85 offset:5632
    ds_read_b64 v[96:97], v85 offset:6144
    ds_read_b64 v[98:99], v85 offset:6656
    ds_read_b64 v[100:101], v85 offset:7168
    ds_read_b64 v[102:103], v85 offset:7680
    ds_read_b64 v[104:105], v85 offset:8192
    ds_read_b64 v[106:107], v85 offset:8704
    ds_read_b64 v[108:109], v85 offset:9216
    ds_read_b64 v[110:111], v85 offset:9728
    ds_read_b64 v[112:113], v85 offset:10240
    ds_read_b64 v[114:115], v85 offset:10752
    ds_read_b64 v[116:117], v85 offset:11264
    ds_read_b64 v[118:119], v85 offset:11776
    ds_read_b64 v[120:121], v85 offset:12288
    ds_read_b64 v[122:123], v85 offset:12800
    ds_read_b64 v[124:125], v85 offset:13312
    ds_read_b64 v[126:127], v85 offset:13824
    ds_read_b64 v[128:129], v85 offset:14336
    ds_read_b64 v[130:131], v85 offset:14848
    ds_read_b64 v[132:133], v85 offset:15360
    ds_read_b64 v[134:135], v85 offset:15872
    ds_read_b64 v[136:137], v85 offset:16384
    ds_read_b64 v[138:139], v85 offset:16896
    ds_read_b64 v[140:141], v85 offset:17408
    ds_read_b64 v[142:143], v85 offset:17920
    ds_read_b64 v[144:145], v85 offset:18432
    ds_read_b64 v[146:147], v85 offset:18944
    ds_read_b64 v[148:149], v85 offset:19456
    ds_read_b64 v[150:151], v85 offset:19968
    s_waitcnt lgkmcnt(0)
    v_add_f32 v88, v88, v90
    v_add_f32 v89, v89, v91
    v_add_f32 v88, v88, v92
    v_add_f32 v89, v89, v93
    v_add_f32 v88, v88, v94
    v_add_f32 v89, v89, v95
    v_add_f32 v88, v88, v96
    v_add_f32 v89, v89, v97
    v_add_f32 v88, v88, v98
    v_add_f32 v89, v89, v99
    v_add_f32 v88, v88, v100
    v_add_f32 v89, v89, v101
    v_add_f32 v88, v88, v102
    v_add_f32 v89, v89, v103
    v_add_f32 v88, v88, v104
    v_add_f32 v89, v89, v105
    v_add_f32 v88, v88, v106
    v_add_f32 v89, v89, v107
    v_add_f32 v88, v88, v108
    v_add_f32 v89, v89, v109
    v_add_f32 v88, v88, v110
    v_add_f32 v89, v89, v111
    v_add_f32 v88, v88, v112
    v_add_f32 v89, v89, v113
    v_add_f32 v88, v88, v114
    v_add_f32 v89, v89, v115
    v_add_f32 v88, v88, v116
    v_add_f32 v89, v89, v117
    v_add_f32 v88, v88, v118
    v_add_f32 v89, v89, v119
    v_add_f32 v88, v88, v120
    v_add_f32 v89, v89, v121
    v_add_f32 v88, v88, v122
    v_add_f32 v89, v89, v123
    v_add_f32 v88, v88, v124
    v_add_f32 v89, v89, v125
    v_add_f32 v88, v88, v126
    v_add_f32 v89, v89, v127
    v_add_f32 v88, v88, v128
    v_add_f32 v89, v89, v129
    v_add_f32 v88, v88, v130
    v_add_f32 v89, v89, v131
    v_add_f32 v88, v88, v132
    v_add_f32 v89, v89, v133
    v_add_f32 v88, v88, v134
    v_add_f32 v89, v89, v135
    v_add_f32 v88, v88, v136
    v_add_f32 v89, v89, v137
    v_add_f32 v88, v88, v138
    v_add_f32 v89, v89, v139
    v_add_f32 v88, v88, v140
    v_add_f32 v89, v89, v141
    v_add_f32 v88, v88, v142
    v_add_f32 v89, v89, v143
    v_add_f32 v88, v88, v144
    v_add_f32 v89, v89, v145
    v_add_f32 v88, v88, v146
    v_add_f32 v89, v89, v147
    v_add_f32 v88, v88, v148
    v_add_f32 v89, v89, v149
    v_add_f32 v88, v88, v150
    v_add_f32 v89, v89, v151
    s_lshl_b32 s9, s84, 3
    s_add_u32 s9, s9, s3
    s_lshl_b32 s9, s9, 2
    s_add_u32 s9, s9, s87
    s_lshl_b32 s9, s9, 2
    s_add_u32 s9, s9, s86
    s_lshl_b32 s9, s9, 9
    s_add_u32 s9, s9, 0x80000
    buffer_store_dwordx2 v[88:89], v85, s[60:63], s9 offen sc1
    s_waitcnt vmcnt(0)
    v_mov_b32 v90, 1
    s_lshl_b32 s9, s3, 5
    s_mov_b64 exec, 1
    buffer_atomic_add v90, off, s[76:79], s9 sc1
    s_mov_b64 exec, -1
    s_barrier
    v_lshlrev_b32 v84, 11, v9
    v_lshl_add_u32 v84, v39, 7, v84
    v_lshl_add_u32 v84, v36, 5, v84
    s_mov_b32 s90, 0
    s_sleep 32
L_pollq:
    buffer_load_dword v88, off, s[76:79], s9 sc1
    s_waitcnt vmcnt(0)
    v_cmp_gt_u32 vcc, 32, v88
    s_nop 0
    s_cmp_eq_u64 vcc, 0
    s_cbranch_scc1 L_pollq_done
    s_add_u32 s90, s90, 1
    s_cmp_lt_u32 s90, 20000
    s_sleep 32
    s_cbranch_scc1 L_pollq
L_pollq_done:
    s_add_u32 s6, s3, 0
    s_lshl_b32 s6, s6, 13
    s_add_u32 s6, s6, 0x80000
    buffer_load_dwordx4 v[88:91], v84, s[60:63], s6 offen offset:0 sc1
    buffer_load_dwordx4 v[92:95], v84, s[60:63], s6 offen offset:16 sc1
    buffer_load_dwordx4 v[96:99], v84, s[60:63], s6 offen offset:512 sc1
    buffer_load_dwordx4 v[100:103], v84, s[60:63], s6 offen offset:528 sc1
    buffer_load_dwordx4 v[104:107], v84, s[60:63], s6 offen offset:1024 sc1
    buffer_load_dwordx4 v[108:111], v84, s[60:63], s6 offen offset:1040 sc1
    buffer_load_dwordx4 v[112:115], v84, s[60:63], s6 offen offset:1536 sc1
    buffer_load_dwordx4 v[116:119], v84, s[60:63], s6 offen offset:1552 sc1
    s_add_u32 s6, s3, 8
    s_lshl_b32 s6, s6, 13
    s_add_u32 s6, s6, 0x80000
    buffer_load_dwordx4 v[120:123], v84, s[60:63], s6 offen offset:0 sc1
    buffer_load_dwordx4 v[124:127], v84, s[60:63], s6 offen offset:16 sc1
    buffer_load_dwordx4 v[128:131], v84, s[60:63], s6 offen offset:512 sc1
    buffer_load_dwordx4 v[132:135], v84, s[60:63], s6 offen offset:528 sc1
    buffer_load_dwordx4 v[136:139], v84, s[60:63], s6 offen offset:1024 sc1
    buffer_load_dwordx4 v[140:143], v84, s[60:63], s6 offen offset:1040 sc1
    buffer_load_dwordx4 v[144:147], v84, s[60:63], s6 offen offset:1536 sc1
    buffer_load_dwordx4 v[148:151], v84, s[60:63], s6 offen offset:1552 sc1
    s_waitcnt vmcnt(0)
    v_add_f32 v88, v88, v96
    v_add_f32 v104, v104, v112
    v_add_f32 v89, v89, v97
    v_add_f32 v105, v105, v113
    v_add_f32 v90, v90, v98
    v_add_f32 v106, v106, v114
    v_add_f32 v91, v91, v99
    v_add_f32 v107, v107, v115
    v_add_f32 v92, v92, v100
    v_add_f32 v108, v108, v116
    v_add_f32 v93, v93, v101
    v_add_f32 v109, v109, v117
    v_add_f32 v94, v94, v102
    v_add_f32 v110, v110, v118
    v_add_f32 v95, v95, v103
    v_add_f32 v111, v111, v119
    v_add_f32 v88, v88, v104
    v_add_f32 v89, v89, v105
    v_add_f32 v90, v90, v106
    v_add_f32 v91, v91, v107
    v_add_f32 v92, v92, v108
    v_add_f32 v93, v93, v109
    v_add_f32 v94, v94, v110
    v_add_f32 v95, v95, v111
    v_cvt_pk_bf16_f32 v10, v88, v89
    v_cvt_pk_bf16_f32 v11, v90, v91
    v_cvt_pk_bf16_f32 v12, v92, v93
    v_cvt_pk_bf16_f32 v13, v94, v95
    ds_write_b128 v2, v[10:13] offset:0
    v_add_f32 v120, v120, v128
    v_add_f32 v136, v136, v144
    v_add_f32 v121, v121, v129
    v_add_f32 v137, v137, v145
    v_add_f32 v122, v122, v130
    v_add_f32 v138, v138, v146
    v_add_f32 v123, v123, v131
    v_add_f32 v139, v139, v147
    v_add_f32 v124, v124, v132
    v_add_f32 v140, v140, v148
    v_add_f32 v125, v125, v133
    v_add_f32 v141, v141, v149
    v_add_f32 v126, v126, v134
    v_add_f32 v142, v142, v150
    v_add_f32 v127, v127, v135
    v_add_f32 v143, v143, v151
    v_add_f32 v120, v120, v136
    v_add_f32 v121, v121, v137
    v_add_f32 v122, v122, v138
    v_add_f32 v123, v123, v139
    v_add_f32 v124, v124, v140
    v_add_f32 v125, v125, v141
    v_add_f32 v126, v126, v142
    v_add_f32 v127, v127, v143
    v_cvt_pk_bf16_f32 v14, v120, v121
    v_cvt_pk_bf16_f32 v15, v122, v123
    v_cvt_pk_bf16_f32 v16, v124, v125
    v_cvt_pk_bf16_f32 v17, v126, v127
    ds_write_b128 v2, v[14:17] offset:1024
    s_waitcnt lgkmcnt(0)
    buffer_load_dwordx4 v[240:243], v87, s[72:75], s11 offen offset:0 nt
    buffer_load_dwordx4 v[244:247], v87, s[72:75], s11 offen offset:1024 nt
    buffer_load_dwordx4 v[248:251], v87, s[72:75], s11 offen offset:2048 nt
    buffer_load_dwordx4 v[252:255], v87, s[72:75], s11 offen offset:3072 nt
    s_add_u32 s6, s12, 0
    buffer_load_dwordx4 v[88:91], v1, s[44:47], s6 offen offset:0 nt
    s_add_u32 s6, s12, 0
    buffer_load_dwordx4 v[92:95], v1, s[44:47], s6 offen offset:1024 nt
    s_add_u32 s6, s12, 0
    buffer_load_dwordx4 v[96:99], v1, s[44:47], s6 offen offset:2048 nt
    s_add_u32 s6, s12, 0
    buffer_load_dwordx4 v[100:103], v1, s[44:47], s6 offen offset:3072 nt
    s_add_u32 s6, s12, 4096
    buffer_load_dwordx4 v[104:107], v1, s[44:47], s6 offen offset:0 nt
    s_add_u32 s6, s12, 4096
    buffer_load_dwordx4 v[108:111], v1, s[44:47], s6 offen offset:1024 nt
    s_add_u32 s6, s12, 4096
    buffer_load_dwordx4 v[112:115], v1, s[44:47], s6 offen offset:2048 nt
    s_add_u32 s6, s12, 4096
    buffer_load_dwordx4 v[116:119], v1, s[44:47], s6 offen offset:3072 nt
    s_add_u32 s6, s12, 8192
    buffer_load_dwordx4 v[120:123], v1, s[44:47], s6 offen offset:0 nt
    s_add_u32 s6, s12, 8192
    buffer_load_dwordx4 v[124:127], v1, s[44:47], s6 offen offset:1024 nt
    s_add_u32 s6, s12, 8192
    buffer_load_dwordx4 v[128:131], v1, s[44:47], s6 offen offset:2048 nt
    s_add_u32 s6, s12, 8192
    buffer_load_dwordx4 v[132:135], v1, s[44:47], s6 offen offset:3072 nt
    s_add_u32 s6, s12, 12288
    buffer_load_dwordx4 v[136:139], v1, s[44:47], s6 offen offset:0 nt
    s_add_u32 s6, s12, 12288
    buffer_load_dwordx4 v[140:143], v1, s[44:47], s6 offen offset:1024 nt
    s_add_u32 s6, s12, 12288
    buffer_load_dwordx4 v[144:147], v1, s[44:47], s6 offen offset:2048 nt
    s_add_u32 s6, s12, 12288
    buffer_load_dwordx4 v[148:151], v1, s[44:47], s6 offen offset:3072 nt
    s_add_u32 s6, s12, 16384
    buffer_load_dwordx4 v[152:155], v1, s[44:47], s6 offen offset:0 nt
    s_add_u32 s6, s12, 16384
    buffer_load_dwordx4 v[156:159], v1, s[44:47], s6 offen offset:1024 nt
    s_add_u32 s6, s12, 16384
    buffer_load_dwordx4 v[160:163], v1, s[44:47], s6 offen offset:2048 nt
    s_add_u32 s6, s12, 16384
    buffer_load_dwordx4 v[164:167], v1, s[44:47], s6 offen offset:3072 nt
    s_add_u32 s6, s12, 20480
    buffer_load_dwordx4 v[168:171], v1, s[44:47], s6 offen offset:0 nt
    s_add_u32 s6, s12, 20480
    buffer_load_dwordx4 v[172:175], v1, s[44:47], s6 offen offset:1024 nt
    s_add_u32 s6, s12, 20480
    buffer_load_dwordx4 v[176:179], v1, s[44:47], s6 offen offset:2048 nt
    s_add_u32 s6, s12, 20480
    buffer_load_dwordx4 v[180:183], v1, s[44:47], s6 offen offset:3072 nt
    s_add_u32 s6, s12, 24576
    buffer_load_dwordx4 v[184:187], v1, s[44:47], s6 offen offset:0 nt
    s_add_u32 s6, s12, 24576
    buffer_load_dwordx4 v[188:191], v1, s[44:47], s6 offen offset:1024 nt
    s_add_u32 s6, s12, 24576
    buffer_load_dwordx4 v[192:195], v1, s[44:47], s6 offen offset:2048 nt
    s_add_u32 s6, s12, 24576
    buffer_load_dwordx4 v[196:199], v1, s[44:47], s6 offen offset:3072 nt
    s_add_u32 s6, s12, 28672
    buffer_load_dwordx4 v[200:203], v1, s[44:47], s6 offen offset:0 nt
    s_add_u32 s6, s12, 28672
    buffer_load_dwordx4 v[204:207], v1, s[44:47], s6 offen offset:1024 nt
    s_add_u32 s6, s12, 28672
    buffer_load_dwordx4 v[208:211], v1, s[44:47], s6 offen offset:2048 nt
    s_add_u32 s6, s12, 28672
    buffer_load_dwordx4 v[212:215], v1, s[44:47], s6 offen offset:3072 nt
    s_add_u32 s6, s12, 0
    buffer_load_dwordx4 v[216:219], v2, s[48:51], s6 offen offset:0 nt
    s_add_u32 s6, s12, 0
    buffer_load_dwordx4 v[220:223], v2, s[48:51], s6 offen offset:1024 nt
    s_add_u32 s6, s12, 0
    buffer_load_dwordx4 v[224:227], v2, s[48:51], s6 offen offset:2048 nt
    s_add_u32 s6, s12, 0
    buffer_load_dwordx4 v[228:231], v2, s[48:51], s6 offen offset:3072 nt
    s_add_u32 s6, s12, 4096
    buffer_load_dwordx4 v[232:235], v2, s[48:51], s6 offen offset:0 nt
    s_add_u32 s6, s12, 5120
    s_add_u32 m0, s95, 0
    s_nop 0
    buffer_load_dwordx4 v2, s[48:51], s6 offen nt lds
    s_add_u32 s6, s12, 6144
    s_add_u32 m0, s95, 1024
    s_nop 0
    buffer_load_dwordx4 v2, s[48:51], s6 offen nt lds
    s_add_u32 s6, s12, 7168
    s_add_u32 m0, s95, 2048
    s_nop 0
    buffer_load_dwordx4 v2, s[48:51], s6 offen nt lds
    s_add_u32 s6, s12, 8192
    s_add_u32 m0, s95, 3072
    s_nop 0
    buffer_load_dwordx4 v2, s[48:51], s6 offen nt lds
    s_add_u32 s6, s12, 9216
    s_add_u32 m0, s95, 4096
    s_nop 0
    buffer_load_dwordx4 v2, s[48:51], s6 offen nt lds
    s_add_u32 s6, s12, 10240
    s_add_u32 m0, s95, 5120
    s_nop 0
    buffer_load_dwordx4 v2, s[48:51], s6 offen nt lds
    s_add_u32 s6, s12, 11264
    s_add_u32 m0, s95, 6144
    s_nop 0
    buffer_load_dwordx4 v2, s[48:51], s6 offen nt lds
    s_add_u32 s6, s12, 12288
    s_add_u32 m0, s95, 7168
    s_nop 0
    buffer_load_dwordx4 v2, s[48:51], s6 offen nt lds
    s_add_u32 s6, s12, 13312
    s_add_u32 m0, s95, 8192
    s_nop 0
    buffer_load_dwordx4 v2, s[48:51], s6 offen nt lds
    s_add_u32 s6, s12, 14336
    s_add_u32 m0, s95, 9216
    s_nop 0
    buffer_load_dwordx4 v2, s[48:51], s6 offen nt lds
    s_add_u32 s6, s12, 15360
    s_add_u32 m0, s95, 10240
    s_nop 0
    buffer_load_dwordx4 v2, s[48:51], s6 offen nt lds
    s_add_u32 s6, s12, 16384
    s_add_u32 m0, s95, 11264
    s_nop 0
    buffer_load_dwordx4 v2, s[48:51], s6 offen nt lds
    s_add_u32 s6, s12, 17408
    s_add_u32 m0, s95, 12288
    s_nop 0
    buffer_load_dwordx4 v2, s[48:51], s6 offen nt lds
    s_add_u32 s6, s12, 18432
    s_add_u32 m0, s95, 13312
    s_nop 0
    buffer_load_dwordx4 v2, s[48:51], s6 offen nt lds
    s_add_u32 s6, s12, 19456
    s_add_u32 m0, s95, 14336
    s_nop 0
    buffer_load_dwordx4 v2, s[48:51], s6 offen nt lds
    s_add_u32 s6, s12, 20480
    s_add_u32 m0, s95, 15360
    s_nop 0
    buffer_load_dwordx4 v2, s[48:51], s6 offen nt lds
    s_add_u32 s6, s12, 21504
    s_add_u32 m0, s95, 16384
    s_nop 0
    buffer_load_dwordx4 v2, s[48:51], s6 offen nt lds
    s_add_u32 s6, s12, 22528
    s_add_u32 m0, s95, 17408
    s_nop 0
    buffer_load_dwordx4 v2, s[48:51], s6 offen nt lds
L_q_wait:
    s_barrier
L_q_go:
    ds_read_b128 v[10:13], v2 offset:0
    ds_read_b128 v[14:17], v2 offset:1024
    s_waitcnt lgkmcnt(0)
    s_waitcnt vmcnt(54)
    v_mfma_f32_16x16x32_bf16 v[40:43], v[88:91], v[10:13], 0
    s_add_u32 s6, s12, 20480
    buffer_load_dwordx4 v[88:91], v2, s[48:51], s6 offen offset:3072 nt
    s_waitcnt vmcnt(54)
    v_mfma_f32_16x16x32_bf16 v[44:47], v[92:95], v[10:13], 0
    s_add_u32 s6, s12, 24576
    buffer_load_dwordx4 v[92:95], v2, s[48:51], s6 offen offset:0 nt
    s_waitcnt vmcnt(54)
    v_mfma_f32_16x16x32_bf16 v[48:51], v[96:99], v[10:13], 0
    s_add_u32 s6, s12, 24576
    buffer_load_dwordx4 v[96:99], v2, s[48:51], s6 offen offset:1024 nt
    v_mov_b32_dpp v56, v40 quad_perm:[0,0,0,0] row_mask:0xf bank_mask:0xf
    v_add_f32_dpp v56, v41, v56 quad_perm:[1,1,1,1] row_mask:0xf bank_mask:0xf
    v_add_f32_dpp v56, v42, v56 quad_perm:[2,2,2,2] row_mask:0xf bank_mask:0xf
    v_add_f32_dpp v56, v43, v56 quad_perm:[3,3,3,3] row_mask:0xf bank_mask:0xf
    s_waitcnt vmcnt(54)
    v_mfma_f32_16x16x32_bf16 v[52:55], v[100:103], v[10:13], 0
    s_add_u32 s6, s12, 24576
    buffer_load_dwordx4 v[100:103], v2, s[48:51], s6 offen offset:2048 nt
    v_mov_b32_dpp v57, v44 quad_perm:[0,0,0,0] row_mask:0xf bank_mask:0xf
    v_add_f32_dpp v57, v45, v57 quad_perm:[1,1,1,1] row_mask:0xf bank_mask:0xf
    v_add_f32_dpp v57, v46, v57 quad_perm:[2,2,2,2] row_mask:0xf bank_mask:0xf
    v_add_f32_dpp v57, v47, v57 quad_perm:[3,3,3,3] row_mask:0xf bank_mask:0xf
    s_waitcnt vmcnt(54)
    v_mfma_f32_16x16x32_bf16 v[40:43], v[104:107], v[10:13], 0
    s_add_u32 s6, s12, 24576
    buffer_load_dwordx4 v[104:107], v2, s[48:51], s6 offen offset:3072 nt
    v_mov_b32_dpp v58, v48 quad_perm:[0,0,0,0] row_mask:0xf bank_mask:0xf
    v_add_f32_dpp v58, v49, v58 quad_perm:[1,1,1,1] row_mask:0xf bank_mask:0xf
    v_add_f32_dpp v58, v50, v58 quad_perm:[2,2,2,2] row_mask:0xf bank_mask:0xf
    v_add_f32_dpp v58, v51, v58 quad_perm:[3,3,3,3] row_mask:0xf bank_mask:0xf
    s_waitcnt vmcnt(54)
    v_mfma_f32_16x16x32_bf16 v[44:47], v[108:111], v[10:13], 0
    s_add_u32 s6, s12, 28672
    buffer_load_dwordx4 v[108:111], v2, s[48:51], s6 offen offset:0 nt
    v_mov_b32_dpp v59, v52 quad_perm:[0,0,0,0] row_mask:0xf bank_mask:0xf
    v_add_f32_dpp v59, v53, v59 quad_perm:[1,1,1,1] row_mask:0xf bank_mask:0xf
    v_add_f32_dpp v59, v54, v59 quad_perm:[2,2,2,2] row_mask:0xf bank_mask:0xf
    v_add_f32_dpp v59, v55, v59 quad_perm:[3,3,3,3] row_mask:0xf bank_mask:0xf
    s_waitcnt vmcnt(54)
    v_mfma_f32_16x16x32_bf16 v[48:51], v[112:115], v[10:13], 0
    s_add_u32 s6, s12, 28672
    buffer_load_dwordx4 v[112:115], v2, s[48:51], s6 offen offset:1024 nt
    v_mov_b32_dpp v60, v40 quad_perm:[0,0,0,0] row_mask:0xf bank_mask:0xf
    v_add_f32_dpp v60, v41, v60 quad_perm:[1,1,1,1] row_mask:0xf bank_mask:0xf
    v_add_f32_dpp v60, v42, v60 quad_perm:[2,2,2,2] row_mask:0xf bank_mask:0xf
    v_add_f32_dpp v60, v43, v60 quad_perm:[3,3,3,3] row_mask:0xf bank_mask:0xf
    s_waitcnt vmcnt(54)
    v_mfma_f32_16x16x32_bf16 v[52:55], v[116:119], v[10:13], 0
    s_add_u32 s6, s12, 28672
    buffer_load_dwordx4 v[116:119], v2, s[48:51], s6 offen offset:2048 nt
    v_mov_b32_dpp v61, v44 quad_perm:[0,0,0,0] row_mask:0xf bank_mask:0xf
    v_add_f32_dpp v61, v45, v61 quad_perm:[1,1,1,1] row_mask:0xf bank_mask:0xf
    v_add_f32_dpp v61, v46, v61 quad_perm:[2,2,2,2] row_mask:0xf bank_mask:0xf
    v_add_f32_dpp v61, v47, v61 quad_perm:[3,3,3,3] row_mask:0xf bank_mask:0xf
    s_waitcnt vmcnt(54)
    v_mfma_f32_16x16x32_bf16 v[40:43], v[120:123], v[10:13], 0
    s_add_u32 s6, s12, 28672
    buffer_load_dwordx4 v[120:123], v2, s[48:51], s6 offen offset:3072 nt
    v_mov_b32_dpp v62, v48 quad_perm:[0,0,0,0] row_mask:0xf bank_mask:0xf
    v_add_f32_dpp v62, v49, v62 quad_perm:[1,1,1,1] row_mask:0xf bank_mask:0xf
    v_add_f32_dpp v62, v50, v62 quad_perm:[2,2,2,2] row_mask:0xf bank_mask:0xf
    v_add_f32_dpp v62, v51, v62 quad_perm:[3,3,3,3] row_mask:0xf bank_mask:0xf
    s_waitcnt vmcnt(54)
    v_mfma_f32_16x16x32_bf16 v[44:47], v[124:127], v[10:13], 0
    s_add_u32 s6, s13, 0
    buffer_load_dwordx4 v[124:127], v1, s[52:55], s6 offen offset:0 nt
    v_mov_b32_dpp v63, v52 quad_perm:[0,0,0,0] row_mask:0xf bank_mask:0xf
    v_add_f32_dpp v63, v53, v63 quad_perm:[1,1,1,1] row_mask:0xf bank_mask:0xf
    v_add_f32_dpp v63, v54, v63 quad_perm:[2,2,2,2] row_mask:0xf bank_mask:0xf
    v_add_f32_dpp v63, v55, v63 quad_perm:[3,3,3,3] row_mask:0xf bank_mask:0xf
    s_waitcnt vmcnt(54)
    v_mfma_f32_16x16x32_bf16 v[48:51], v[128:131], v[10:13], 0
    s_add_u32 s6, s13, 0
    buffer_load_dwordx4 v[128:131], v1, s[52:55], s6 offen offset:1024 nt
    v_mov_b32_dpp v64, v40 quad_perm:[0,0,0,0] row_mask:0xf bank_mask:0xf
    v_add_f32_dpp v64, v41, v64 quad_perm:[1,1,1,1] row_mask:0xf bank_mask:0xf
    v_add_f32_dpp v64, v42, v64 quad_perm:[2,2,2,2] row_mask:0xf bank_mask:0xf
    v_add_f32_dpp v64, v43, v64 quad_perm:[3,3,3,3] row_mask:0xf bank_mask:0xf
    s_waitcnt vmcnt(54)
    v_mfma_f32_16x16x32_bf16 v[52:55], v[132:135], v[10:13], 0
    s_add_u32 s6, s13, 0
    buffer_load_dwordx4 v[132:135], v1, s[52:55], s6 offen offset:2048 nt
    v_mov_b32_dpp v65, v44 quad_perm:[0,0,0,0] row_mask:0xf bank_mask:0xf
    v_add_f32_dpp v65, v45, v65 quad_perm:[1,1,1,1] row_mask:0xf bank_mask:0xf
    v_add_f32_dpp v65, v46, v65 quad_perm:[2,2,2,2] row_mask:0xf bank_mask:0xf
    v_add_f32_dpp v65, v47, v65 quad_perm:[3,3,3,3] row_mask:0xf bank_mask:0xf
    s_waitcnt vmcnt(54)
    v_mfma_f32_16x16x32_bf16 v[40:43], v[136:139], v[10:13], 0
    s_add_u32 s6, s13, 0
    buffer_load_dwordx4 v[136:139], v1, s[52:55], s6 offen offset:3072 nt
    v_mov_b32_dpp v66, v48 quad_perm:[0,0,0,0] row_mask:0xf bank_mask:0xf
    v_add_f32_dpp v66, v49, v66 quad_perm:[1,1,1,1] row_mask:0xf bank_mask:0xf
    v_add_f32_dpp v66, v50, v66 quad_perm:[2,2,2,2] row_mask:0xf bank_mask:0xf
    v_add_f32_dpp v66, v51, v66 quad_perm:[3,3,3,3] row_mask:0xf bank_mask:0xf
    s_waitcnt vmcnt(54)
    v_mfma_f32_16x16x32_bf16 v[44:47], v[140:143], v[10:13], 0
    s_add_u32 s6, s13, 0
    buffer_load_dwordx4 v[140:143], v2, s[56:59], s6 offen offset:0 nt
    v_mov_b32_dpp v67, v52 quad_perm:[0,0,0,0] row_mask:0xf bank_mask:0xf
    v_add_f32_dpp v67, v53, v67 quad_perm:[1,1,1,1] row_mask:0xf bank_mask:0xf
    v_add_f32_dpp v67, v54, v67 quad_perm:[2,2,2,2] row_mask:0xf bank_mask:0xf
    v_add_f32_dpp v67, v55, v67 quad_perm:[3,3,3,3] row_mask:0xf bank_mask:0xf
    s_waitcnt vmcnt(54)
    v_mfma_f32_16x16x32_bf16 v[48:51], v[144:147], v[10:13], 0
    s_add_u32 s6, s13, 0
    buffer_load_dwordx4 v[144:147], v2, s[56:59], s6 offen offset:1024 nt
    v_mov_b32_dpp v68, v40 quad_perm:[0,0,0,0] row_mask:0xf bank_mask:0xf
    v_add_f32_dpp v68, v41, v68 quad_perm:[1,1,1,1] row_mask:0xf bank_mask:0xf
    v_add_f32_dpp v68, v42, v68 quad_perm:[2,2,2,2] row_mask:0xf bank_mask:0xf
    v_add_f32_dpp v68, v43, v68 quad_perm:[3,3,3,3] row_mask:0xf bank_mask:0xf
    s_waitcnt vmcnt(54)
    v_mfma_f32_16x16x32_bf16 v[52:55], v[148:151], v[10:13], 0
    s_add_u32 s6, s13, 0
    buffer_load_dwordx4 v[148:151], v2, s[56:59], s6 offen offset:2048 nt
    v_mov_b32_dpp v69, v44 quad_perm:[0,0,0,0] row_mask:0xf bank_mask:0xf
    v_add_f32_dpp v69, v45, v69 quad_perm:[1,1,1,1] row_mask:0xf bank_mask:0xf
    v_add_f32_dpp v69, v46, v69 quad_perm:[2,2,2,2] row_mask:0xf bank_mask:0xf
    v_add_f32_dpp v69, v47, v69 quad_perm:[3,3,3,3] row_mask:0xf bank_mask:0xf
    s_waitcnt vmcnt(54)
    v_mfma_f32_16x16x32_bf16 v[40:43], v[152:155], v[10:13], 0
    s_add_u32 s6, s13, 0
    buffer_load_dwordx4 v[152:155], v2, s[56:59], s6 offen offset:3072 nt
    v_mov_b32_dpp v70, v48 quad_perm:[0,0,0,0] row_mask:0xf bank_mask:0xf
    v_add_f32_dpp v70, v49, v70 quad_perm:[1,1,1,1] row_mask:0xf bank_mask:0xf
    v_add_f32_dpp v70, v50, v70 quad_perm:[2,2,2,2] row_mask:0xf bank_mask:0xf
    v_add_f32_dpp v70, v51, v70 quad_perm:[3,3,3,3] row_mask:0xf bank_mask:0xf
    s_waitcnt vmcnt(54)
    v_mfma_f32_16x16x32_bf16 v[44:47], v[156:159], v[10:13], 0
    v_mov_b32_dpp v71, v52 quad_perm:[0,0,0,0] row_mask:0xf bank_mask:0xf
    v_add_f32_dpp v71, v53, v71 quad_perm:[1,1,1,1] row_mask:0xf bank_mask:0xf
    v_add_f32_dpp v71, v54, v71 quad_perm:[2,2,2,2] row_mask:0xf bank_mask:0xf
    v_add_f32_dpp v71, v55, v71 quad_perm:[3,3,3,3] row_mask:0xf bank_mask:0xf
    s_waitcnt vmcnt(53)
    v_mfma_f32_16x16x32_bf16 v[48:51], v[160:163], v[10:13], 0
    v_mov_b32_dpp v72, v40 quad_perm:[0,0,0,0] row_mask:0xf bank_mask:0xf
    v_add_f32_dpp v72, v41, v72 quad_perm:[1,1,1,1] row_mask:0xf bank_mask:0xf
    v_add_f32_dpp v72, v42, v72 quad_perm:[2,2,2,2] row_mask:0xf bank_mask:0xf
    v_add_f32_dpp v72, v43, v72 quad_perm:[3,3,3,3] row_mask:0xf bank_mask:0xf
    s_waitcnt vmcnt(52)
    v_mfma_f32_16x16x32_bf16 v[52:55], v[164:167], v[10:13], 0
    v_mov_b32_dpp v73, v44 quad_perm:[0,0,0,0] row_mask:0xf bank_mask:0xf
    v_add_f32_dpp v73, v45, v73 quad_perm:[1,1,1,1] row_mask:0xf bank_mask:0xf
    v_add_f32_dpp v73, v46, v73 quad_perm:[2,2,2,2] row_mask:0xf bank_mask:0xf
    v_add_f32_dpp v73, v47, v73 quad_perm:[3,3,3,3] row_mask:0xf bank_mask:0xf
    s_waitcnt vmcnt(51)
    v_mfma_f32_16x16x32_bf16 v[40:43], v[168:171], v[10:13], 0
    v_mov_b32_dpp v74, v48 quad_perm:[0,0,0,0] row_mask:0xf bank_mask:0xf
    v_add_f32_dpp v74, v49, v74 quad_perm:[1,1,1,1] row_mask:0xf bank_mask:0xf
    v_add_f32_dpp v74, v50, v74 quad_perm:[2,2,2,2] row_mask:0xf bank_mask:0xf
    v_add_f32_dpp v74, v51, v74 quad_perm:[3,3,3,3] row_mask:0xf bank_mask:0xf
    s_waitcnt vmcnt(50)
    v_mfma_f32_16x16x32_bf16 v[44:47], v[172:175], v[10:13], 0
    v_mov_b32_dpp v75, v52 quad_perm:[0,0,0,0] row_mask:0xf bank_mask:0xf
    v_add_f32_dpp v75, v53, v75 quad_perm:[1,1,1,1] row_mask:0xf bank_mask:0xf
    v_add_f32_dpp v75, v54, v75 quad_perm:[2,2,2,2] row_mask:0xf bank_mask:0xf
    v_add_f32_dpp v75, v55, v75 quad_perm:[3,3,3,3] row_mask:0xf bank_mask:0xf
    s_waitcnt vmcnt(49)
    v_mfma_f32_16x16x32_bf16 v[48:51], v[176:179], v[10:13], 0
    v_mov_b32_dpp v76, v40 quad_perm:[0,0,0,0] row_mask:0xf bank_mask:0xf
    v_add_f32_dpp v76, v41, v76 quad_perm:[1,1,1,1] row_mask:0xf bank_mask:0xf
    v_add_f32_dpp v76, v42, v76 quad_perm:[2,2,2,2] row_mask:0xf bank_mask:0xf
    v_add_f32_dpp v76, v43, v76 quad_perm:[3,3,3,3] row_mask:0xf bank_mask:0xf
    s_waitcnt vmcnt(48)
    v_mfma_f32_16x16x32_bf16 v[52:55], v[180:183], v[10:13], 0
    v_mov_b32_dpp v77, v44 quad_perm:[0,0,0,0] row_mask:0xf bank_mask:0xf
    v_add_f32_dpp v77, v45, v77 quad_perm:[1,1,1,1] row_mask:0xf bank_mask:0xf
    v_add_f32_dpp v77, v46, v77 quad_perm:[2,2,2,2] row_mask:0xf bank_mask:0xf
    v_add_f32_dpp v77, v47, v77 quad_perm:[3,3,3,3] row_mask:0xf bank_mask:0xf
    s_waitcnt vmcnt(47)
    v_mfma_f32_16x16x32_bf16 v[40:43], v[184:187], v[10:13], 0
    v_mov_b32_dpp v78, v48 quad_perm:[0,0,0,0] row_mask:0xf bank_mask:0xf
    v_add_f32_dpp v78, v49, v78 quad_perm:[1,1,1,1] row_mask:0xf bank_mask:0xf
    v_add_f32_dpp v78, v50, v78 quad_perm:[2,2,2,2] row_mask:0xf bank_mask:0xf
    v_add_f32_dpp v78, v51, v78 quad_perm:[3,3,3,3] row_mask:0xf bank_mask:0xf
    s_waitcnt vmcnt(46)
    v_mfma_f32_16x16x32_bf16 v[44:47], v[188:191], v[10:13], 0
    v_mov_b32_dpp v79, v52 quad_perm:[0,0,0,0] row_mask:0xf bank_mask:0xf
    v_add_f32_dpp v79, v53, v79 quad_perm:[1,1,1,1] row_mask:0xf bank_mask:0xf
    v_add_f32_dpp v79, v54, v79 quad_perm:[2,2,2,2] row_mask:0xf bank_mask:0xf
    v_add_f32_dpp v79, v55, v79 quad_perm:[3,3,3,3] row_mask:0xf bank_mask:0xf
    s_waitcnt vmcnt(45)
    v_mfma_f32_16x16x32_bf16 v[48:51], v[192:195], v[10:13], 0
    v_mov_b32_dpp v80, v40 quad_perm:[0,0,0,0] row_mask:0xf bank_mask:0xf
    v_add_f32_dpp v80, v41, v80 quad_perm:[1,1,1,1] row_mask:0xf bank_mask:0xf
    v_add_f32_dpp v80, v42, v80 quad_perm:[2,2,2,2] row_mask:0xf bank_mask:0xf
    v_add_f32_dpp v80, v43, v80 quad_perm:[3,3,3,3] row_mask:0xf bank_mask:0xf
    s_waitcnt vmcnt(44)
    v_mfma_f32_16x16x32_bf16 v[52:55], v[196:199], v[10:13], 0
    v_mov_b32_dpp v81, v44 quad_perm:[0,0,0,0] row_mask:0xf bank_mask:0xf
    v_add_f32_dpp v81, v45, v81 quad_perm:[1,1,1,1] row_mask:0xf bank_mask:0xf
    v_add_f32_dpp v81, v46, v81 quad_perm:[2,2,2,2] row_mask:0xf bank_mask:0xf
    v_add_f32_dpp v81, v47, v81 quad_perm:[3,3,3,3] row_mask:0xf bank_mask:0xf
    s_waitcnt vmcnt(43)
    v_mfma_f32_16x16x32_bf16 v[40:43], v[200:203], v[10:13], 0
    v_mov_b32_dpp v82, v48 quad_perm:[0,0,0,0] row_mask:0xf bank_mask:0xf
    v_add_f32_dpp v82, v49, v82 quad_perm:[1,1,1,1] row_mask:0xf bank_mask:0xf
    v_add_f32_dpp v82, v50, v82 quad_perm:[2,2,2,2] row_mask:0xf bank_mask:0xf
    v_add_f32_dpp v82, v51, v82 quad_perm:[3,3,3,3] row_mask:0xf bank_mask:0xf
    s_waitcnt vmcnt(42)
    v_mfma_f32_16x16x32_bf16 v[44:47], v[204:207], v[10:13], 0
    v_mov_b32_dpp v83, v52 quad_perm:[0,0,0,0] row_mask:0xf bank_mask:0xf
    v_add_f32_dpp v83, v53, v83 quad_perm:[1,1,1,1] row_mask:0xf bank_mask:0xf
    v_add_f32_dpp v83, v54, v83 quad_perm:[2,2,2,2] row_mask:0xf bank_mask:0xf
    v_add_f32_dpp v83, v55, v83 quad_perm:[3,3,3,3] row_mask:0xf bank_mask:0xf
    s_waitcnt vmcnt(41)
    v_mfma_f32_16x16x32_bf16 v[48:51], v[208:211], v[10:13], 0
    v_mov_b32_dpp v84, v40 quad_perm:[0,0,0,0] row_mask:0xf bank_mask:0xf
    v_add_f32_dpp v84, v41, v84 quad_perm:[1,1,1,1] row_mask:0xf bank_mask:0xf
    v_add_f32_dpp v84, v42, v84 quad_perm:[2,2,2,2] row_mask:0xf bank_mask:0xf
    v_add_f32_dpp v84, v43, v84 quad_perm:[3,3,3,3] row_mask:0xf bank_mask:0xf
    s_waitcnt vmcnt(40)
    v_mfma_f32_16x16x32_bf16 v[52:55], v[212:215], v[10:13], 0
    v_mov_b32_dpp v85, v44 quad_perm:[0,0,0,0] row_mask:0xf bank_mask:0xf
    v_add_f32_dpp v85, v45, v85 quad_perm:[1,1,1,1] row_mask:0xf bank_mask:0xf
    v_add_f32_dpp v85, v46, v85 quad_perm:[2,2,2,2] row_mask:0xf bank_mask:0xf
    v_add_f32_dpp v85, v47, v85 quad_perm:[3,3,3,3] row_mask:0xf bank_mask:0xf
    v_mov_b32_dpp v86, v48 quad_perm:[0,0,0,0] row_mask:0xf bank_mask:0xf
    v_add_f32_dpp v86, v49, v86 quad_perm:[1,1,1,1] row_mask:0xf bank_mask:0xf
    v_add_f32_dpp v86, v50, v86 quad_perm:[2,2,2,2] row_mask:0xf bank_mask:0xf
    v_add_f32_dpp v86, v51, v86 quad_perm:[3,3,3,3] row_mask:0xf bank_mask:0xf
    v_mov_b32_dpp v87, v52 quad_perm:[0,0,0,0] row_mask:0xf bank_mask:0xf
    v_add_f32_dpp v87, v53, v87 quad_perm:[1,1,1,1] row_mask:0xf bank_mask:0xf
    v_add_f32_dpp v87, v54, v87 quad_perm:[2,2,2,2] row_mask:0xf bank_mask:0xf
    v_add_f32_dpp v87, v55, v87 quad_perm:[3,3,3,3] row_mask:0xf bank_mask:0xf
    v_max_f32 v36, v56, v57
    v_max3_f32 v36, v36, v58, v59
    v_max3_f32 v36, v36, v60, v61
    v_max3_f32 v36, v36, v62, v63
    v_max3_f32 v36, v36, v64, v65
    v_max3_f32 v36, v36, v66, v67
    v_max3_f32 v36, v36, v68, v69
    v_max3_f32 v36, v36, v70, v71
    v_max3_f32 v36, v36, v72, v73
    v_max3_f32 v36, v36, v74, v75
    v_max3_f32 v36, v36, v76, v77
    v_max3_f32 v36, v36, v78, v79
    v_max3_f32 v36, v36, v80, v81
    v_max3_f32 v36, v36, v82, v83
    v_max3_f32 v36, v36, v84, v85
    v_max3_f32 v36, v36, v86, v87
    ds_bpermute_b32 v8, v5, v36
    s_waitcnt lgkmcnt(0)
    v_max_f32 v36, v36, v8
    ds_bpermute_b32 v8, v6, v36
    s_waitcnt lgkmcnt(0)
    v_max_f32 v36, v36, v8
    v_mul_f32 v37, s15, v36
    v_fma_f32 v56, v56, s15, -v37
    v_fma_f32 v57, v57, s15, -v37
    v_fma_f32 v58, v58, s15, -v37
    v_fma_f32 v59, v59, s15, -v37
    v_fma_f32 v60, v60, s15, -v37
    v_fma_f32 v61, v61, s15, -v37
    v_fma_f32 v62, v62, s15, -v37
    v_fma_f32 v63, v63, s15, -v37
    v_fma_f32 v64, v64, s15, -v37
    v_fma_f32 v65, v65, s15, -v37
    v_fma_f32 v66, v66, s15, -v37
    v_fma_f32 v67, v67, s15, -v37
    v_fma_f32 v68, v68, s15, -v37
    v_fma_f32 v69, v69, s15, -v37
    v_fma_f32 v70, v70, s15, -v37
    v_fma_f32 v71, v71, s15, -v37
    v_fma_f32 v72, v72, s15, -v37
    v_fma_f32 v73, v73, s15, -v37
    v_fma_f32 v74, v74, s15, -v37
    v_fma_f32 v75, v75, s15, -v37
    v_fma_f32 v76, v76, s15, -v37
    v_fma_f32 v77, v77, s15, -v37
    v_fma_f32 v78, v78, s15, -v37
    v_fma_f32 v79, v79, s15, -v37
    v_fma_f32 v80, v80, s15, -v37
    v_fma_f32 v81, v81, s15, -v37
    v_fma_f32 v82, v82, s15, -v37
    v_fma_f32 v83, v83, s15, -v37
    v_fma_f32 v84, v84, s15, -v37
    v_fma_f32 v85, v85, s15, -v37
    v_fma_f32 v86, v86, s15, -v37
    v_fma_f32 v87, v87, s15, -v37
    v_exp_f32 v56, v56
    v_exp_f32 v57, v57
    v_exp_f32 v58, v58
    v_exp_f32 v59, v59
    v_exp_f32 v60, v60
    v_exp_f32 v61, v61
    v_exp_f32 v62, v62
    v_exp_f32 v63, v63
    v_exp_f32 v64, v64
    v_exp_f32 v65, v65
    v_exp_f32 v66, v66
    v_exp_f32 v67, v67
    v_exp_f32 v68, v68
    v_exp_f32 v69, v69
    v_exp_f32 v70, v70
    v_exp_f32 v71, v71
    v_exp_f32 v72, v72
    v_exp_f32 v73, v73
    v_exp_f32 v74, v74
    v_exp_f32 v75, v75
    v_exp_f32 v76, v76
    v_exp_f32 v77, v77
    v_exp_f32 v78, v78
    v_exp_f32 v79, v79
    v_exp_f32 v80, v80
    v_exp_f32 v81, v81
    v_exp_f32 v82, v82
    v_exp_f32 v83, v83
    v_exp_f32 v84, v84
    v_exp_f32 v85, v85
    v_exp_f32 v86, v86
    v_exp_f32 v87, v87
    v_add_f32 v38, v56, v57
    v_add_f32 v38, v38, v58
    v_add_f32 v38, v38, v59
    v_add_f32 v38, v38, v60
    v_add_f32 v38, v38, v61
    v_add_f32 v38, v38, v62
    v_add_f32 v38, v38, v63
    v_add_f32 v38, v38, v64
    v_add_f32 v38, v38, v65
    v_add_f32 v38, v38, v66
    v_add_f32 v38, v38, v67
    v_add_f32 v38, v38, v68
    v_add_f32 v38, v38, v69
    v_add_f32 v38, v38, v70
    v_add_f32 v38, v38, v71
    v_add_f32 v38, v38, v72
    v_add_f32 v38, v38, v73
    v_add_f32 v38, v38, v74
    v_add_f32 v38, v38, v75
    v_add_f32 v38, v38, v76
    v_add_f32 v38, v38, v77
    v_add_f32 v38, v38, v78
    v_add_f32 v38, v38, v79
    v_add_f32 v38, v38, v80
    v_add_f32 v38, v38, v81
    v_add_f32 v38, v38, v82
    v_add_f32 v38, v38, v83
    v_add_f32 v38, v38, v84
    v_add_f32 v38, v38, v85
    v_add_f32 v38, v38, v86
    v_add_f32 v38, v38, v87
    v_cvt_pk_bf16_f32 v9, v56, v56
    v_and_b32 v20, v9, v3
    v_and_b32 v21, v9, v4
    v_cvt_pk_bf16_f32 v9, v57, v57
    v_and_b32 v24, v9, v3
    v_and_b32 v25, v9, v4
    s_waitcnt vmcnt(39)
    v_mfma_f32_16x16x32_bf16 v[28:31], v[216:219], v[20:23], 0
    v_mfma_f32_16x16x32_bf16 v[32:35], v[216:219], v[18:21], 0
    v_cvt_pk_bf16_f32 v9, v58, v58
    v_and_b32 v20, v9, v3
    v_and_b32 v21, v9, v4
    s_waitcnt vmcnt(38)
    v_mfma_f32_16x16x32_bf16 v[28:31], v[220:223], v[24:27], v[28:31]
    v_mfma_f32_16x16x32_bf16 v[32:35], v[220:223], v[22:25], v[32:35]
    v_cvt_pk_bf16_f32 v9, v59, v59
    v_and_b32 v24, v9, v3
    v_and_b32 v25, v9, v4
    s_waitcnt vmcnt(37)
    v_mfma_f32_16x16x32_bf16 v[28:31], v[224:227], v[20:23], v[28:31]
    v_mfma_f32_16x16x32_bf16 v[32:35], v[224:227], v[18:21], v[32:35]
    v_cvt_pk_bf16_f32 v9, v60, v60
    v_and_b32 v20, v9, v3
    v_and_b32 v21, v9, v4
    s_waitcnt vmcnt(34)
    ds_read_b128 v[156:159], v239 offset:0
    s_waitcnt vmcnt(36)
    v_mfma_f32_16x16x32_bf16 v[28:31], v[228:231], v[24:27], v[28:31]
    v_mfma_f32_16x16x32_bf16 v[32:35], v[228:231], v[22:25], v[32:35]
    v_cvt_pk_bf16_f32 v9, v61, v61
    v_and_b32 v24, v9, v3
    v_and_b32 v25, v9, v4
    s_waitcnt vmcnt(33)
    ds_read_b128 v[160:163], v239 offset:1024
    s_waitcnt vmcnt(35)
    v_mfma_f32_16x16x32_bf16 v[28:31], v[232:235], v[20:23], v[28:31]
    v_mfma_f32_16x16x32_bf16 v[32:35], v[232:235], v[18:21], v[32:35]
    v_cvt_pk_bf16_f32 v9, v62, v62
    v_and_b32 v20, v9, v3
    v_and_b32 v21, v9, v4
    s_waitcnt vmcnt(32)
    ds_read_b128 v[164:167], v239 offset:2048
    s_waitcnt lgkmcnt(2)
    v_mfma_f32_16x16x32_bf16 v[28:31], v[156:159], v[24:27], v[28:31]
    v_mfma_f32_16x16x32_bf16 v[32:35], v[156:159], v[22:25], v[32:35]
    v_cvt_pk_bf16_f32 v9, v63, v63
    v_and_b32 v24, v9, v3
    v_and_b32 v25, v9, v4
    s_waitcnt vmcnt(31)
    ds_read_b128 v[168:171], v239 offset:3072
    s_waitcnt lgkmcnt(2)
    v_mfma_f32_16x16x32_bf16 v[28:31], v[160:163], v[20:23], v[28:31]
    v_mfma_f32_16x16x32_bf16 v[32:35], v[160:163], v[18:21], v[32:35]
    v_cvt_pk_bf16_f32 v9, v64, v64
    v_and_b32 v20, v9, v3
    v_and_b32 v21, v9, v4
    s_waitcnt vmcnt(30)
    ds_read_b128 v[172:175], v239 offset:4096
    s_waitcnt lgkmcnt(2)
    v_mfma_f32_16x16x32_bf16 v[28:31], v[164:167], v[24:27], v[28:31]
    v_mfma_f32_16x16x32_bf16 v[32:35], v[164:167], v[22:25], v[32:35]
    v_cvt_pk_bf16_f32 v9, v65, v65
    v_and_b32 v24, v9, v3
    v_and_b32 v25, v9, v4
    s_waitcnt vmcnt(29)
    ds_read_b128 v[176:179], v239 offset:5120
    s_waitcnt lgkmcnt(2)
    v_mfma_f32_16x16x32_bf16 v[28:31], v[168:171], v[20:23], v[28:31]
    v_mfma_f32_16x16x32_bf16 v[32:35], v[168:171], v[18:21], v[32:35]
    v_cvt_pk_bf16_f32 v9, v66, v66
    v_and_b32 v20, v9, v3
    v_and_b32 v21, v9, v4
    s_waitcnt vmcnt(28)
    ds_read_b128 v[180:183], v239 offset:6144
    s_waitcnt lgkmcnt(2)
    v_mfma_f32_16x16x32_bf16 v[28:31], v[172:175], v[24:27], v[28:31]
    v_mfma_f32_16x16x32_bf16 v[32:35], v[172:175], v[22:25], v[32:35]
    v_cvt_pk_bf16_f32 v9, v67, v67
    v_and_b32 v24, v9, v3
    v_and_b32 v25, v9, v4
    s_waitcnt vmcnt(27)
    ds_read_b128 v[184:187], v239 offset:7168
    s_waitcnt lgkmcnt(2)
    v_mfma_f32_16x16x32_bf16 v[28:31], v[176:179], v[20:23], v[28:31]
    v_mfma_f32_16x16x32_bf16 v[32:35], v[176:179], v[18:21], v[32:35]
    v_cvt_pk_bf16_f32 v9, v68, v68
    v_and_b32 v20, v9, v3
    v_and_b32 v21, v9, v4
    s_waitcnt vmcnt(26)
    ds_read_b128 v[188:191], v239 offset:8192
    s_waitcnt lgkmcnt(2)
    v_mfma_f32_16x16x32_bf16 v[28:31], v[180:183], v[24:27], v[28:31]
    v_mfma_f32_16x16x32_bf16 v[32:35], v[180:183], v[22:25], v[32:35]
    v_cvt_pk_bf16_f32 v9, v69, v69
    v_and_b32 v24, v9, v3
    v_and_b32 v25, v9, v4
    s_waitcnt vmcnt(25)
    ds_read_b128 v[192:195], v239 offset:9216
    s_waitcnt lgkmcnt(2)
    v_mfma_f32_16x16x32_bf16 v[28:31], v[184:187], v[20:23], v[28:31]
    v_mfma_f32_16x16x32_bf16 v[32:35], v[184:187], v[18:21], v[32:35]
    v_cvt_pk_bf16_f32 v9, v70, v70
    v_and_b32 v20, v9, v3
    v_and_b32 v21, v9, v4
    s_waitcnt vmcnt(24)
    ds_read_b128 v[196:199], v239 offset:10240
    s_waitcnt lgkmcnt(2)
    v_mfma_f32_16x16x32_bf16 v[28:31], v[188:191], v[24:27], v[28:31]
    v_mfma_f32_16x16x32_bf16 v[32:35], v[188:191], v[22:25], v[32:35]
    v_cvt_pk_bf16_f32 v9, v71, v71
    v_and_b32 v24, v9, v3
    v_and_b32 v25, v9, v4
    s_waitcnt vmcnt(23)
    ds_read_b128 v[200:203], v239 offset:11264
    s_waitcnt lgkmcnt(2)
    v_mfma_f32_16x16x32_bf16 v[28:31], v[192:195], v[20:23], v[28:31]
    v_mfma_f32_16x16x32_bf16 v[32:35], v[192:195], v[18:21], v[32:35]
    v_cvt_pk_bf16_f32 v9, v72, v72
    v_and_b32 v20, v9, v3
    v_and_b32 v21, v9, v4
    s_waitcnt vmcnt(22)
    ds_read_b128 v[204:207], v239 offset:12288
    s_waitcnt lgkmcnt(2)
    v_mfma_f32_16x16x32_bf16 v[28:31], v[196:199], v[24:27], v[28:31]
    v_mfma_f32_16x16x32_bf16 v[32:35], v[196:199], v[22:25], v[32:35]
    v_cvt_pk_bf16_f32 v9, v73, v73
    v_and_b32 v24, v9, v3
    v_and_b32 v25, v9, v4
    s_waitcnt vmcnt(21)
    ds_read_b128 v[208:211], v239 offset:13312
    s_waitcnt lgkmcnt(2)
    v_mfma_f32_16x16x32_bf16 v[28:31], v[200:203], v[20:23], v[28:31]
    v_mfma_f32_16x16x32_bf16 v[32:35], v[200:203], v[18:21], v[32:35]
    v_cvt_pk_bf16_f32 v9, v74, v74
    v_and_b32 v20, v9, v3
    v_and_b32 v21, v9, v4
    s_waitcnt vmcnt(20)
    ds_read_b128 v[212:215], v239 offset:14336
    s_waitcnt lgkmcnt(2)
    v_mfma_f32_16x16x32_bf16 v[28:31], v[204:207], v[24:27], v[28:31]
    v_mfma_f32_16x16x32_bf16 v[32:35], v[204:207], v[22:25], v[32:35]
    v_cvt_pk_bf16_f32 v9, v75, v75
    v_and_b32 v24, v9, v3
    v_and_b32 v25, v9, v4
    s_waitcnt vmcnt(19)
    ds_read_b128 v[216:219], v239 offset:15360
    s_waitcnt lgkmcnt(2)
    v_mfma_f32_16x16x32_bf16 v[28:31], v[208:211], v[20:23], v[28:31]
    v_mfma_f32_16x16x32_bf16 v[32:35], v[208:211], v[18:21], v[32:35]
    v_cvt_pk_bf16_f32 v9, v76, v76
    v_and_b32 v20, v9, v3
    v_and_b32 v21, v9, v4
    s_waitcnt vmcnt(18)
    ds_read_b128 v[220:223], v239 offset:16384
    s_waitcnt lgkmcnt(2)
    v_mfma_f32_16x16x32_bf16 v[28:31], v[212:215], v[24:27], v[28:31]
    v_mfma_f32_16x16x32_bf16 v[32:35], v[212:215], v[22:25], v[32:35]
    v_cvt_pk_bf16_f32 v9, v77, v77
    v_and_b32 v24, v9, v3
    v_and_b32 v25, v9, v4
    s_waitcnt vmcnt(17)
    ds_read_b128 v[224:227], v239 offset:17408
    s_waitcnt lgkmcnt(2)
    v_mfma_f32_16x16x32_bf16 v[28:31], v[216:219], v[20:23], v[28:31]
    v_mfma_f32_16x16x32_bf16 v[32:35], v[216:219], v[18:21], v[32:35]
    v_cvt_pk_bf16_f32 v9, v78, v78
    v_and_b32 v20, v9, v3
    v_and_b32 v21, v9, v4
    s_waitcnt lgkmcnt(1)
    v_mfma_f32_16x16x32_bf16 v[28:31], v[220:223], v[24:27], v[28:31]
    v_mfma_f32_16x16x32_bf16 v[32:35], v[220:223], v[22:25], v[32:35]
    v_cvt_pk_bf16_f32 v9, v79, v79
    v_and_b32 v24, v9, v3
    v_and_b32 v25, v9, v4
    s_waitcnt lgkmcnt(0)
    v_mfma_f32_16x16x32_bf16 v[28:31], v[224:227], v[20:23], v[28:31]
    v_mfma_f32_16x16x32_bf16 v[32:35], v[224:227], v[18:21], v[32:35]
    v_cvt_pk_bf16_f32 v9, v80, v80
    v_and_b32 v20, v9, v3
    v_and_b32 v21, v9, v4
    s_waitcnt vmcnt(16)
    v_mfma_f32_16x16x32_bf16 v[28:31], v[88:91], v[24:27], v[28:31]
    v_mfma_f32_16x16x32_bf16 v[32:35], v[88:91], v[22:25], v[32:35]
    v_cvt_pk_bf16_f32 v9, v81, v81
    v_and_b32 v24, v9, v3
    v_and_b32 v25, v9, v4
    s_waitcnt vmcnt(15)
    v_mfma_f32_16x16x32_bf16 v[28:31], v[92:95], v[20:23], v[28:31]
    v_mfma_f32_16x16x32_bf16 v[32:35], v[92:95], v[18:21], v[32:35]
    v_cvt_pk_bf16_f32 v9, v82, v82
    v_and_b32 v20, v9, v3
    v_and_b32 v21, v9, v4
    s_waitcnt vmcnt(14)
    v_mfma_f32_16x16x32_bf16 v[28:31], v[96:99], v[24:27], v[28:31]
    v_mfma_f32_16x16x32_bf16 v[32:35], v[96:99], v[22:25], v[32:35]
    v_cvt_pk_bf16_f32 v9, v83, v83
    v_and_b32 v24, v9, v3
    v_and_b32 v25, v9, v4
    s_waitcnt vmcnt(13)
    v_mfma_f32_16x16x32_bf16 v[28:31], v[100:103], v[20:23], v[28:31]
    v_mfma_f32_16x16x32_bf16 v[32:35], v[100:103], v[18:21], v[32:35]
    v_cvt_pk_bf16_f32 v9, v84, v84
    v_and_b32 v20, v9, v3
    v_and_b32 v21, v9, v4
    s_waitcnt vmcnt(12)
    v_mfma_f32_16x16x32_bf16 v[28:31], v[104:107], v[24:27], v[28:31]
    v_mfma_f32_16x16x32_bf16 v[32:35], v[104:107], v[22:25], v[32:35]
    v_cvt_pk_bf16_f32 v9, v85, v85
    v_and_b32 v24, v9, v3
    v_and_b32 v25, v9, v4
    s_waitcnt vmcnt(11)
    v_mfma_f32_16x16x32_bf16 v[28:31], v[108:111], v[20:23], v[28:31]
    v_mfma_f32_16x16x32_bf16 v[32:35], v[108:111], v[18:21], v[32:35]
    v_cvt_pk_bf16_f32 v9, v86, v86
    v_and_b32 v20, v9, v3
    v_and_b32 v21, v9, v4
    s_waitcnt vmcnt(10)
    v_mfma_f32_16x16x32_bf16 v[28:31], v[112:115], v[24:27], v[28:31]
    v_mfma_f32_16x16x32_bf16 v[32:35], v[112:115], v[22:25], v[32:35]
    v_cvt_pk_bf16_f32 v9, v87, v87
    v_and_b32 v24, v9, v3
    v_and_b32 v25, v9, v4
    s_waitcnt vmcnt(9)
    v_mfma_f32_16x16x32_bf16 v[28:31], v[116:119], v[20:23], v[28:31]
    v_mfma_f32_16x16x32_bf16 v[32:35], v[116:119], v[18:21], v[32:35]
    s_waitcnt vmcnt(8)
    v_mfma_f32_16x16x32_bf16 v[28:31], v[120:123], v[24:27], v[28:31]
    v_mfma_f32_16x16x32_bf16 v[32:35], v[120:123], v[22:25], v[32:35]
    ds_bpermute_b32 v8, v5, v38
    s_waitcnt lgkmcnt(0)
    v_add_f32 v38, v38, v8
    ds_bpermute_b32 v8, v6, v38
    s_waitcnt lgkmcnt(0)
    v_add_f32 v37, v38, v8
    s_nop 0
    ds_write_b32 v7, v28 offset:0
    ds_write_b32 v7, v32 offset:16
    ds_write_b32 v7, v29 offset:32
    ds_write_b32 v7, v33 offset:48
    ds_write_b32 v7, v30 offset:64
    ds_write_b32 v7, v34 offset:80
    ds_write_b32 v7, v31 offset:96
    ds_write_b32 v7, v35 offset:112
    v_bfe_u32 v8, v0, 2, 2
    v_lshlrev_b32 v8, 3, v8
    s_lshl_b32 s6, s5, 5
    v_add_u32 v8, s6, v8
    ds_write_b64 v8, v[36:37] offset:2048
    s_waitcnt vmcnt(7)
    v_mfma_f32_16x16x32_bf16 v[40:43], v[124:127], v[14:17], 0
    s_waitcnt vmcnt(6)
    v_mfma_f32_16x16x32_bf16 v[44:47], v[128:131], v[14:17], 0
    s_waitcnt vmcnt(5)
    v_mfma_f32_16x16x32_bf16 v[48:51], v[132:135], v[14:17], 0
    s_nop 3
    v_mov_b32_dpp v56, v40 quad_perm:[0,0,0,0] row_mask:0xf bank_mask:0xf
    v_add_f32_dpp v56, v41, v56 quad_perm:[1,1,1,1] row_mask:0xf bank_mask:0xf
    v_add_f32_dpp v56, v42, v56 quad_perm:[2,2,2,2] row_mask:0xf bank_mask:0xf
    v_add_f32_dpp v56, v43, v56 quad_perm:[3,3,3,3] row_mask:0xf bank_mask:0xf
    s_waitcnt vmcnt(4)
    v_mfma_f32_16x16x32_bf16 v[52:55], v[136:139], v[14:17], 0
    v_mov_b32_dpp v57, v44 quad_perm:[0,0,0,0] row_mask:0xf bank_mask:0xf
    v_add_f32_dpp v57, v45, v57 quad_perm:[1,1,1,1] row_mask:0xf bank_mask:0xf
    v_add_f32_dpp v57, v46, v57 quad_perm:[2,2,2,2] row_mask:0xf bank_mask:0xf
    v_add_f32_dpp v57, v47, v57 quad_perm:[3,3,3,3] row_mask:0xf bank_mask:0xf
    v_mov_b32_dpp v58, v48 quad_perm:[0,0,0,0] row_mask:0xf bank_mask:0xf
    v_add_f32_dpp v58, v49, v58 quad_perm:[1,1,1,1] row_mask:0xf bank_mask:0xf
    v_add_f32_dpp v58, v50, v58 quad_perm:[2,2,2,2] row_mask:0xf bank_mask:0xf
    v_add_f32_dpp v58, v51, v58 quad_perm:[3,3,3,3] row_mask:0xf bank_mask:0xf
    v_mov_b32_dpp v59, v52 quad_perm:[0,0,0,0] row_mask:0xf bank_mask:0xf
    v_add_f32_dpp v59, v53, v59 quad_perm:[1,1,1,1] row_mask:0xf bank_mask:0xf
    v_add_f32_dpp v59, v54, v59 quad_perm:[2,2,2,2] row_mask:0xf bank_mask:0xf
    v_add_f32_dpp v59, v55, v59 quad_perm:[3,3,3,3] row_mask:0xf bank_mask:0xf
    v_max_f32 v36, v56, v57
    v_max3_f32 v36, v36, v58, v59
    ds_bpermute_b32 v8, v5, v36
    s_waitcnt lgkmcnt(0)
    v_max_f32 v36, v36, v8
    ds_bpermute_b32 v8, v6, v36
    s_waitcnt lgkmcnt(0)
    v_max_f32 v36, v36, v8
    v_mul_f32 v37, s15, v36
    v_fma_f32 v56, v56, s15, -v37
    v_fma_f32 v57, v57, s15, -v37
    v_fma_f32 v58, v58, s15, -v37
    v_fma_f32 v59, v59, s15, -v37
    v_exp_f32 v56, v56
    v_exp_f32 v57, v57
    v_exp_f32 v58, v58
    v_exp_f32 v59, v59
    v_add_f32 v38, v56, v57
    v_add_f32 v38, v38, v58
    v_add_f32 v38, v38, v59
    v_cvt_pk_bf16_f32 v9, v56, v56
    v_and_b32 v20, v9, v3
    v_and_b32 v21, v9, v4
    v_cvt_pk_bf16_f32 v9, v57, v57
    v_and_b32 v24, v9, v3
    v_and_b32 v25, v9, v4
    s_waitcnt vmcnt(3)
    v_mfma_f32_16x16x32_bf16 v[28:31], v[140:143], v[20:23], 0
    v_mfma_f32_16x16x32_bf16 v[32:35], v[140:143], v[18:21], 0
    v_cvt_pk_bf16_f32 v9, v58, v58
    v_and_b32 v20, v9, v3
    v_and_b32 v21, v9, v4
    s_waitcnt vmcnt(2)
    v_mfma_f32_16x16x32_bf16 v[28:31], v[144:147], v[24:27], v[28:31]
    v_mfma_f32_16x16x32_bf16 v[32:35], v[144:147], v[22:25], v[32:35]
    v_cvt_pk_bf16_f32 v9, v59, v59
    v_and_b32 v24, v9, v3
    v_and_b32 v25, v9, v4
    s_waitcnt vmcnt(1)
    v_mfma_f32_16x16x32_bf16 v[28:31], v[148:151], v[20:23], v[28:31]
    v_mfma_f32_16x16x32_bf16 v[32:35], v[148:151], v[18:21], v[32:35]
    s_waitcnt vmcnt(0)
    v_mfma_f32_16x16x32_bf16 v[28:31], v[152:155], v[24:27], v[28:31]
    v_mfma_f32_16x16x32_bf16 v[32:35], v[152:155], v[22:25], v[32:35]
    ds_bpermute_b32 v8, v5, v38
    s_waitcnt lgkmcnt(0)
    v_add_f32 v38, v38, v8
    ds_bpermute_b32 v8, v6, v38
    s_waitcnt lgkmcnt(0)
    v_add_f32 v37, v38, v8
    s_nop 0
    ds_write_b32 v7, v28 offset:2048
    ds_write_b32 v7, v32 offset:2064
    ds_write_b32 v7, v29 offset:2080
    ds_write_b32 v7, v33 offset:2096
    ds_write_b32 v7, v30 offset:2112
    ds_write_b32 v7, v34 offset:2128
    ds_write_b32 v7, v31 offset:2144
    ds_write_b32 v7, v35 offset:2160
    v_bfe_u32 v8, v0, 2, 2
    v_lshlrev_b32 v8, 3, v8
    s_lshl_b32 s6, s5, 5
    v_add_u32 v8, s6, v8
    ds_write_b64 v8, v[36:37] offset:2304
    s_waitcnt lgkmcnt(0)
    s_barrier
    v_and_b32 v8, 63, v0
    s_lshr_b32 s6, s5, 2
    s_and_b32 s7, s5, 3
    s_lshl_b32 s8, s6, 11
    s_lshl_b32 s9, s7, 9
    s_add_u32 s8, s8, s9
    s_add_u32 s8, s8, 4096
    v_lshlrev_b32 v9, 3, v8
    v_add_u32 v39, s8, v9
    v_add_u32 v38, 73728, v39
    s_lshl_b32 s8, s6, 8
    s_lshl_b32 s9, s7, 3
    s_add_u32 s8, s8, s9
    v_mov_b32 v8, s8
    ds_read_b64 v[104:105], v8 offset:2048
    ds_read_b64 v[106:107], v8 offset:2080
    ds_read_b64 v[108:109], v8 offset:2112
    ds_read_b64 v[110:111], v8 offset:2144
    ds_read_b64 v[112:113], v8 offset:2176
    ds_read_b64 v[114:115], v8 offset:2208
    ds_read_b64 v[116:117], v8 offset:2240
    ds_read_b64 v[118:119], v8 offset:2272
    ds_read_b64 v[88:89], v39 offset:0
    ds_read_b64 v[90:91], v39 offset:18432
    ds_read_b64 v[92:93], v39 offset:36864
    ds_read_b64 v[94:95], v39 offset:55296
    ds_read_b64 v[96:97], v38 offset:0
    ds_read_b64 v[98:99], v38 offset:18432
    ds_read_b64 v[100:101], v38 offset:36864
    ds_read_b64 v[102:103], v38 offset:55296
    s_waitcnt lgkmcnt(0)
    v_max_f32 v36, v104, v106
    v_max3_f32 v36, v36, v108, v110
    v_max3_f32 v36, v36, v112, v114
    v_max3_f32 v36, v36, v116, v118
    v_mul_f32 v37, s15, v36
    v_fma_f32 v104, v104, s15, -v37
    v_fma_f32 v106, v106, s15, -v37
    v_fma_f32 v108, v108, s15, -v37
    v_fma_f32 v110, v110, s15, -v37
    v_fma_f32 v112, v112, s15, -v37
    v_fma_f32 v114, v114, s15, -v37
    v_fma_f32 v116, v116, s15, -v37
    v_fma_f32 v118, v118, s15, -v37
    v_exp_f32 v104, v104
    v_exp_f32 v106, v106
    v_exp_f32 v108, v108
    v_exp_f32 v110, v110
    v_exp_f32 v112, v112
    v_exp_f32 v114, v114
    v_exp_f32 v116, v116
    v_exp_f32 v118, v118
    v_mul_f32 v37, v104, v105
    v_mul_f32 v28, v104, v88
    v_mul_f32 v29, v104, v89
    v_fmac_f32 v37, v106, v107
    v_fmac_f32 v28, v106, v90
    v_fmac_f32 v29, v106, v91
    v_fmac_f32 v37, v108, v109
    v_fmac_f32 v28, v108, v92
    v_fmac_f32 v29, v108, v93
    v_fmac_f32 v37, v110, v111
    v_fmac_f32 v28, v110, v94
    v_fmac_f32 v29, v110, v95
    v_fmac_f32 v37, v112, v113
    v_fmac_f32 v28, v112, v96
    v_fmac_f32 v29, v112, v97
    v_fmac_f32 v37, v114, v115
    v_fmac_f32 v28, v114, v98
    v_fmac_f32 v29, v114, v99
    v_fmac_f32 v37, v116, v117
    v_fmac_f32 v28, v116, v100
    v_fmac_f32 v29, v116, v101
    v_fmac_f32 v37, v118, v119
    v_fmac_f32 v28, v118, v102
    v_fmac_f32 v29, v118, v103
    v_add_f32 v28, 0, v28
    v_xor_b32 v28, 0x80000000, v28
    v_add_f32 v29, 0, v29
    v_xor_b32 v29, 0x80000000, v29
    v_add_f32 v36, 0, v36
    v_xor_b32 v36, 0x80000000, v36
    v_add_f32 v37, 0, v37
    v_xor_b32 v37, 0x80000000, v37
    s_lshl_b32 s8, s6, 5
    s_lshl_b32 s9, s3, 2
    s_add_u32 s8, s8, s9
    s_add_u32 s8, s8, s7
    s_lshl_b32 s8, s8, 5
    s_add_u32 s8, s8, s4
    s_lshl_b32 s9, s8, 9
    s_add_u32 s9, s9, 0x100000
    buffer_store_dwordx2 v[28:29], v9, s[60:63], s9 offen sc1
    s_lshl_b32 s9, s8, 3
    s_add_u32 s9, s9, 0x8000
    s_mov_b64 exec, 1
    buffer_store_dwordx2 v[36:37], off, s[60:63], s9 sc1
    s_mov_b64 exec, -1
    v_and_b32 v3, 63, v0
    v_and_b32 v4, 31, v0
    v_lshlrev_b32 v5, 3, v4
    s_lshl_b32 s11, s84, 5
    s_add_u32 s11, s11, s88
    s_lshl_b32 s12, s11, 8
    s_add_u32 s12, s12, 0x8000
    v_bfe_u32 v6, v0, 5, 1
    v_lshlrev_b32 v7, 9, v4
    v_lshl_add_u32 v7, v6, 5, v7
    s_lshl_b32 s13, s11, 14
    s_lshl_b32 s6, s5, 6
    s_add_u32 s13, s13, s6
    s_add_u32 s13, s13, 0x100000
    v_xor_b32 v10, 16, v3
    v_lshlrev_b32 v10, 2, v10
    v_bfe_u32 v11, v0, 4, 1
    v_cmp_eq_u32 s[98:99], 1, v11
    v_lshrrev_b32 v1, 4, v0
    v_and_b32 v2, 15, v0
    v_lshlrev_b32 v21, 9, v1
    v_lshl_add_u32 v21, v2, 5, v21
    v_and_b32 v11, 127, v0
    v_lshlrev_b32 v11, 2, v11
    s_mov_b32 s90, 0
    s_cmp_lg_u32 s5, 0
    s_cbranch_scc1 L_poll0_done
    v_and_b32 v22, 7, v0
    v_lshlrev_b32 v22, 5, v22
L_pollz:
    buffer_load_dword v23, v22, s[76:79], 0 offen sc1
    s_waitcnt vmcnt(0)
    v_cmp_gt_u32 vcc, 32, v23
    s_nop 0
    s_cmp_eq_u64 vcc, 0
    s_cbranch_scc1 L_pollz_done
    s_add_u32 s90, s90, 1
    s_cmp_lt_u32 s90, 20000
    s_sleep 32
    s_cbranch_scc1 L_pollz
L_pollz_done:
    s_mov_b32 s90, 0
L_poll0:
    buffer_load_dwordx2 v[8:9], v5, s[60:63], s12 offen sc1
    s_waitcnt vmcnt(0)
    v_min_u32 v20, v8, v9
    v_cmp_eq_u32 vcc, 0, v20
    s_nop 0
    s_bcnt1_i32_b64 s91, vcc
    s_cmp_eq_u32 s91, 0
    s_cbranch_scc1 L_poll0_done
    s_cmp_le_u32 s91, 8
    s_cbranch_scc1 L_poll0_fast
    s_sleep 32
L_poll0_fast:
    s_sleep 4
    s_add_u32 s90, s90, 1
    s_cmp_lt_u32 s90, 20000
    s_cbranch_scc1 L_poll0
L_poll0_done:
    s_barrier
    s_mov_b32 s90, 0
L_poll1:
    buffer_load_dwordx2 v[8:9], v5, s[60:63], s12 offen sc1
    buffer_load_dwordx4 v[12:15], v7, s[60:63], s13 offen sc1
    buffer_load_dwordx4 v[16:19], v7, s[60:63], s13 offen offset:16 sc1
    s_waitcnt vmcnt(0)
    v_min3_u32 v20, v12, v13, v14
    v_min3_u32 v20, v20, v15, v16
    v_min3_u32 v20, v20, v17, v18
    v_min3_u32 v20, v20, v19, v8
    v_min_u32 v20, v20, v9
    v_cmp_eq_u32 vcc, 0, v20
    s_nop 0
    s_cmp_eq_u64 vcc, 0
    s_cbranch_scc1 L_poll1_done
    s_add_u32 s90, s90, 1
    s_cmp_lt_u32 s90, 20000
    s_sleep 4
    s_cbranch_scc1 L_poll1
L_poll1_done:
    v_xor_b32 v8, 0x80000000, v8
    v_mov_b32 v36, v8
    s_nop 1
    v_max_f32_dpp v36, v36, v36 row_ror:1 row_mask:0xf bank_mask:0xf
    s_nop 1
    v_max_f32_dpp v36, v36, v36 row_ror:2 row_mask:0xf bank_mask:0xf
    s_nop 1
    v_max_f32_dpp v36, v36, v36 row_ror:4 row_mask:0xf bank_mask:0xf
    s_nop 1
    v_max_f32_dpp v36, v36, v36 row_ror:8 row_mask:0xf bank_mask:0xf
    ds_bpermute_b32 v37, v10, v36
    s_waitcnt lgkmcnt(0)
    v_max_f32 v36, v36, v37
    v_mul_f32 v36, s15, v36
    v_fma_f32 v38, v8, s15, -v36
    v_exp_f32 v38, v38
    s_nop 0
    v_mul_f32 v9, v38, -v9
    v_mul_f32 v12, v38, -v12
    v_mul_f32 v13, v38, -v13
    v_mul_f32 v14, v38, -v14
    v_mul_f32 v15, v38, -v15
    v_mul_f32 v16, v38, -v16
    v_mul_f32 v17, v38, -v17
    v_mul_f32 v18, v38, -v18
    v_mul_f32 v19, v38, -v19
    v_add_f32_dpp v9, v9, v9 row_ror:1 row_mask:0xf bank_mask:0xf
    v_add_f32_dpp v12, v12, v12 row_ror:1 row_mask:0xf bank_mask:0xf
    v_add_f32_dpp v13, v13, v13 row_ror:1 row_mask:0xf bank_mask:0xf
    v_add_f32_dpp v14, v14, v14 row_ror:1 row_mask:0xf bank_mask:0xf
    v_add_f32_dpp v15, v15, v15 row_ror:1 row_mask:0xf bank_mask:0xf
    v_add_f32_dpp v16, v16, v16 row_ror:1 row_mask:0xf bank_mask:0xf
    v_add_f32_dpp v17, v17, v17 row_ror:1 row_mask:0xf bank_mask:0xf
    v_add_f32_dpp v18, v18, v18 row_ror:1 row_mask:0xf bank_mask:0xf
    v_add_f32_dpp v19, v19, v19 row_ror:1 row_mask:0xf bank_mask:0xf
    v_add_f32_dpp v9, v9, v9 row_ror:2 row_mask:0xf bank_mask:0xf
    v_add_f32_dpp v12, v12, v12 row_ror:2 row_mask:0xf bank_mask:0xf
    v_add_f32_dpp v13, v13, v13 row_ror:2 row_mask:0xf bank_mask:0xf
    v_add_f32_dpp v14, v14, v14 row_ror:2 row_mask:0xf bank_mask:0xf
    v_add_f32_dpp v15, v15, v15 row_ror:2 row_mask:0xf bank_mask:0xf
    v_add_f32_dpp v16, v16, v16 row_ror:2 row_mask:0xf bank_mask:0xf
    v_add_f32_dpp v17, v17, v17 row_ror:2 row_mask:0xf bank_mask:0xf
    v_add_f32_dpp v18, v18, v18 row_ror:2 row_mask:0xf bank_mask:0xf
    v_add_f32_dpp v19, v19, v19 row_ror:2 row_mask:0xf bank_mask:0xf
    v_add_f32_dpp v9, v9, v9 row_ror:4 row_mask:0xf bank_mask:0xf
    v_add_f32_dpp v12, v12, v12 row_ror:4 row_mask:0xf bank_mask:0xf
    v_add_f32_dpp v13, v13, v13 row_ror:4 row_mask:0xf bank_mask:0xf
    v_add_f32_dpp v14, v14, v14 row_ror:4 row_mask:0xf bank_mask:0xf
    v_add_f32_dpp v15, v15, v15 row_ror:4 row_mask:0xf bank_mask:0xf
    v_add_f32_dpp v16, v16, v16 row_ror:4 row_mask:0xf bank_mask:0xf
    v_add_f32_dpp v17, v17, v17 row_ror:4 row_mask:0xf bank_mask:0xf
    v_add_f32_dpp v18, v18, v18 row_ror:4 row_mask:0xf bank_mask:0xf
    v_add_f32_dpp v19, v19, v19 row_ror:4 row_mask:0xf bank_mask:0xf
    v_add_f32_dpp v9, v9, v9 row_ror:8 row_mask:0xf bank_mask:0xf
    v_add_f32_dpp v12, v12, v12 row_ror:8 row_mask:0xf bank_mask:0xf
    v_add_f32_dpp v13, v13, v13 row_ror:8 row_mask:0xf bank_mask:0xf
    v_add_f32_dpp v14, v14, v14 row_ror:8 row_mask:0xf bank_mask:0xf
    v_add_f32_dpp v15, v15, v15 row_ror:8 row_mask:0xf bank_mask:0xf
    v_add_f32_dpp v16, v16, v16 row_ror:8 row_mask:0xf bank_mask:0xf
    v_add_f32_dpp v17, v17, v17 row_ror:8 row_mask:0xf bank_mask:0xf
    v_add_f32_dpp v18, v18, v18 row_ror:8 row_mask:0xf bank_mask:0xf
    v_add_f32_dpp v19, v19, v19 row_ror:8 row_mask:0xf bank_mask:0xf
    ds_bpermute_b32 v40, v10, v9
    ds_bpermute_b32 v41, v10, v12
    ds_bpermute_b32 v42, v10, v13
    ds_bpermute_b32 v43, v10, v14
    ds_bpermute_b32 v44, v10, v15
    ds_bpermute_b32 v45, v10, v16
    ds_bpermute_b32 v46, v10, v17
    ds_bpermute_b32 v47, v10, v18
    ds_bpermute_b32 v48, v10, v19
    s_waitcnt lgkmcnt(0)
    v_add_f32 v9, v9, v40
    v_add_f32 v12, v12, v41
    v_add_f32 v13, v13, v42
    v_add_f32 v14, v14, v43
    v_add_f32 v15, v15, v44
    v_add_f32 v16, v16, v45
    v_add_f32 v17, v17, v46
    v_add_f32 v18, v18, v47
    v_add_f32 v19, v19, v48
    v_rcp_f32 v9, v9
    v_cndmask_b32 v44, v12, v16, s[98:99]
    v_cndmask_b32 v45, v13, v17, s[98:99]
    v_cndmask_b32 v46, v14, v18, s[98:99]
    v_cndmask_b32 v47, v15, v19, s[98:99]
    v_mul_f32 v44, v44, v9
    v_mul_f32 v45, v45, v9
    v_mul_f32 v46, v46, v9
    v_mul_f32 v47, v47, v9
    v_cvt_pk_bf16_f32 v44, v44, v44
    v_cvt_pk_bf16_f32 v45, v45, v45
    v_cvt_pk_bf16_f32 v46, v46, v46
    v_cvt_pk_bf16_f32 v47, v47, v47
    v_lshlrev_b32 v44, 16, v44
    v_lshlrev_b32 v45, 16, v45
    v_lshlrev_b32 v46, 16, v46
    v_lshlrev_b32 v47, 16, v47
    v_lshlrev_b32 v37, 16, v240
    v_and_b32 v38, 0xffff0000, v240
    v_mul_f32 v48, v44, v37
    v_mul_f32 v49, v44, v38
    v_lshlrev_b32 v37, 16, v241
    v_and_b32 v38, 0xffff0000, v241
    v_mul_f32 v50, v44, v37
    v_mul_f32 v51, v44, v38
    v_lshlrev_b32 v37, 16, v242
    v_and_b32 v38, 0xffff0000, v242
    v_mul_f32 v52, v44, v37
    v_mul_f32 v53, v44, v38
    v_lshlrev_b32 v37, 16, v243
    v_and_b32 v38, 0xffff0000, v243
    v_mul_f32 v54, v44, v37
    v_mul_f32 v55, v44, v38
    v_lshlrev_b32 v37, 16, v244
    v_and_b32 v38, 0xffff0000, v244
    v_fmac_f32 v48, v45, v37
    v_fmac_f32 v49, v45, v38
    v_lshlrev_b32 v37, 16, v245
    v_and_b32 v38, 0xffff0000, v245
    v_fmac_f32 v50, v45, v37
    v_fmac_f32 v51, v45, v38
    v_lshlrev_b32 v37, 16, v246
    v_and_b32 v38, 0xffff0000, v246
    v_fmac_f32 v52, v45, v37
    v_fmac_f32 v53, v45, v38
    v_lshlrev_b32 v37, 16, v247
    v_and_b32 v38, 0xffff0000, v247
    v_fmac_f32 v54, v45, v37
    v_fmac_f32 v55, v45, v38
    v_lshlrev_b32 v37, 16, v248
    v_and_b32 v38, 0xffff0000, v248
    v_fmac_f32 v48, v46, v37
    v_fmac_f32 v49, v46, v38
    v_lshlrev_b32 v37, 16, v249
    v_and_b32 v38, 0xffff0000, v249
    v_fmac_f32 v50, v46, v37
    v_fmac_f32 v51, v46, v38
    v_lshlrev_b32 v37, 16, v250
    v_and_b32 v38, 0xffff0000, v250
    v_fmac_f32 v52, v46, v37
    v_fmac_f32 v53, v46, v38
    v_lshlrev_b32 v37, 16, v251
    v_and_b32 v38, 0xffff0000, v251
    v_fmac_f32 v54, v46, v37
    v_fmac_f32 v55, v46, v38
    v_lshlrev_b32 v37, 16, v252
    v_and_b32 v38, 0xffff0000, v252
    v_fmac_f32 v48, v47, v37
    v_fmac_f32 v49, v47, v38
    v_lshlrev_b32 v37, 16, v253
    v_and_b32 v38, 0xffff0000, v253
    v_fmac_f32 v50, v47, v37
    v_fmac_f32 v51, v47, v38
    v_lshlrev_b32 v37, 16, v254
    v_and_b32 v38, 0xffff0000, v254
    v_fmac_f32 v52, v47, v37
    v_fmac_f32 v53, v47, v38
    v_lshlrev_b32 v37, 16, v255
    v_and_b32 v38, 0xffff0000, v255
    v_fmac_f32 v54, v47, v37
    v_fmac_f32 v55, v47, v38
    ds_write_b128 v21, v[48:51] offset:24576
    ds_write_b128 v21, v[52:55] offset:24592
    s_waitcnt lgkmcnt(0)
    s_barrier
    s_lshl_b32 s9, s84, 2
    s_add_u32 s9, s9, s87
    s_cmp_ge_u32 s5, 2
    s_cbranch_scc1 L_after_y
    ds_read_b32 v56, v11 offset:24576
    ds_read_b32 v57, v11 offset:25088
    ds_read_b32 v58, v11 offset:25600
    ds_read_b32 v59, v11 offset:26112
    ds_read_b32 v60, v11 offset:26624
    ds_read_b32 v61, v11 offset:27136
    ds_read_b32 v62, v11 offset:27648
    ds_read_b32 v63, v11 offset:28160
    ds_read_b32 v64, v11 offset:28672
    ds_read_b32 v65, v11 offset:29184
    ds_read_b32 v66, v11 offset:29696
    ds_read_b32 v67, v11 offset:30208
    ds_read_b32 v68, v11 offset:30720
    ds_read_b32 v69, v11 offset:31232
    ds_read_b32 v70, v11 offset:31744
    ds_read_b32 v71, v11 offset:32256
    ds_read_b32 v72, v11 offset:32768
    ds_read_b32 v73, v11 offset:33280
    ds_read_b32 v74, v11 offset:33792
    ds_read_b32 v75, v11 offset:34304
    ds_read_b32 v76, v11 offset:34816
    ds_read_b32 v77, v11 offset:35328
    ds_read_b32 v78, v11 offset:35840
    ds_read_b32 v79, v11 offset:36352
    ds_read_b32 v80, v11 offset:36864
    ds_read_b32 v81, v11 offset:37376
    ds_read_b32 v82, v11 offset:37888
    ds_read_b32 v83, v11 offset:38400
    ds_read_b32 v84, v11 offset:38912
    ds_read_b32 v85, v11 offset:39424
    ds_read_b32 v86, v11 offset:39936
    ds_read_b32 v87, v11 offset:40448
    s_waitcnt lgkmcnt(0)
    v_add_f32 v56, v56, v57
    v_add_f32 v58, v58, v59
    v_add_f32 v60, v60, v61
    v_add_f32 v62, v62, v63
    v_add_f32 v64, v64, v65
    v_add_f32 v66, v66, v67
    v_add_f32 v68, v68, v69
    v_add_f32 v70, v70, v71
    v_add_f32 v72, v72, v73
    v_add_f32 v74, v74, v75
    v_add_f32 v76, v76, v77
    v_add_f32 v78, v78, v79
    v_add_f32 v80, v80, v81
    v_add_f32 v82, v82, v83
    v_add_f32 v84, v84, v85
    v_add_f32 v86, v86, v87
    v_add_f32 v56, v56, v58
    v_add_f32 v60, v60, v62
    v_add_f32 v64, v64, v66
    v_add_f32 v68, v68, v70
    v_add_f32 v72, v72, v74
    v_add_f32 v76, v76, v78
    v_add_f32 v80, v80, v82
    v_add_f32 v84, v84, v86
    v_add_f32 v56, v56, v60
    v_add_f32 v64, v64, v68
    v_add_f32 v72, v72, v76
    v_add_f32 v80, v80, v84
    v_add_f32 v56, v56, v64
    v_add_f32 v72, v72, v80
    v_add_f32 v56, v56, v72
    v_add_f32 v56, 0, v56
    v_xor_b32 v56, 0x80000000, v56
    s_lshl_b32 s10, s9, 5
    s_add_u32 s10, s10, s88
    s_lshl_b32 s10, s10, 9
    s_add_u32 s10, s10, 0x40000
    buffer_store_dword v56, v11, s[60:63], s10 offen sc1
L_after_y:
    s_cmp_lg_u32 s86, 0
    s_cbranch_scc1 L_end
    s_cmp_lg_u32 s9, s3
    s_cbranch_scc1 L_end
    v_lshrrev_b32 v6, 5, v0
    v_lshlrev_b32 v7, 10, v6
    v_lshl_add_u32 v7, v4, 4, v7
    v_lshlrev_b32 v21, 9, v6
    v_lshl_add_u32 v21, v4, 4, v21
    s_lshl_b32 s10, s9, 14
    s_add_u32 s10, s10, 0x40000
    s_mov_b32 s90, 0
L_poll3:
    buffer_load_dwordx4 v[12:15], v7, s[60:63], s10 offen sc1
    buffer_load_dwordx4 v[16:19], v7, s[60:63], s10 offen offset:512 sc1
    s_waitcnt vmcnt(0)
    v_min3_u32 v20, v12, v13, v14
    v_min3_u32 v20, v20, v15, v16
    v_min3_u32 v20, v20, v17, v18
    v_min_u32 v20, v20, v19
    v_cmp_eq_u32 vcc, 0, v20
    s_nop 0
    s_cmp_eq_u64 vcc, 0
    s_cbranch_scc1 L_poll3_done
    s_add_u32 s90, s90, 1
    s_cmp_lt_u32 s90, 20000
    s_sleep 4
    s_cbranch_scc1 L_poll3
L_poll3_done:
    v_sub_f32 v12, -v12, v16
    v_sub_f32 v13, -v13, v17
    v_sub_f32 v14, -v14, v18
    v_sub_f32 v15, -v15, v19
    ds_write_b128 v21, v[12:15] offset:8192
    s_waitcnt lgkmcnt(0)
    s_barrier
    s_cmp_ge_u32 s5, 2
    s_cbranch_scc1 L_end
    ds_read_b32 v44, v11 offset:8192
    ds_read_b32 v45, v11 offset:8704
    ds_read_b32 v46, v11 offset:9216
    ds_read_b32 v47, v11 offset:9728
    ds_read_b32 v48, v11 offset:10240
    ds_read_b32 v49, v11 offset:10752
    ds_read_b32 v50, v11 offset:11264
    ds_read_b32 v51, v11 offset:11776
    ds_read_b32 v52, v11 offset:12288
    ds_read_b32 v53, v11 offset:12800
    ds_read_b32 v54, v11 offset:13312
    ds_read_b32 v55, v11 offset:13824
    ds_read_b32 v56, v11 offset:14336
    ds_read_b32 v57, v11 offset:14848
    ds_read_b32 v58, v11 offset:15360
    ds_read_b32 v59, v11 offset:15872
    s_waitcnt lgkmcnt(0)
    v_add_f32 v44, v44, v45
    v_add_f32 v46, v46, v47
    v_add_f32 v48, v48, v49
    v_add_f32 v50, v50, v51
    v_add_f32 v52, v52, v53
    v_add_f32 v54, v54, v55
    v_add_f32 v56, v56, v57
    v_add_f32 v58, v58, v59
    v_add_f32 v44, v44, v46
    v_add_f32 v48, v48, v50
    v_add_f32 v52, v52, v54
    v_add_f32 v56, v56, v58
    v_add_f32 v44, v44, v48
    v_add_f32 v52, v52, v56
    v_add_f32 v44, v44, v52
    v_cvt_pk_bf16_f32 v44, v44, v44
    v_lshrrev_b32 v11, 1, v11
    s_lshl_b32 s9, s9, 8
    buffer_store_short v44, v11, s[80:83], s9 offen
L_end:
    s_endpgm
.section .rodata,"a"
.p2align 6
.amdhsa_kernel concat_heads__gqa_block_cached__sliding_block_cached__decode_kernel
  .amdhsa_next_free_vgpr 256
  .amdhsa_next_free_sgpr 100
  .amdhsa_accum_offset 256
  .amdhsa_group_segment_fixed_size 0
  .amdhsa_kernarg_size 104
  .amdhsa_user_sgpr_count 2
  .amdhsa_user_sgpr_kernarg_segment_ptr 1
  .amdhsa_system_sgpr_workgroup_id_x 1
.end_amdhsa_kernel
```
